```python
import torch

def _softmax(x, axis=-1):
    return torch.softmax(x, dim=axis)
def _gelu(x):
    return torch.nn.functional.gelu(x, approximate="tanh")
def _silu(x):
    return torch.nn.functional.silu(x)
def _sigmoid(x):
    return torch.sigmoid(x)
def _layernorm(x, axis=-1, eps=1e-5):
    m = x.mean(dim=axis, keepdim=True)
    v = x.var(dim=axis, keepdim=True, unbiased=False)
    return (x - m) / torch.sqrt(v + eps)
def _scatter_add(tgt, idx, src, axis=0):
    return tgt.clone().index_add_(axis, idx, src)
def _segment_sum(src, seg, n):
    out = torch.zeros((n,) + src.shape[1:], dtype=src.dtype)
    return out.index_add_(0, seg, src)
def _pad(x, pw):
    flat = tuple(v for pair in reversed(pw) for v in pair)
    return torch.nn.functional.pad(x, flat)

kernel_name = 'recurrent_scan__sliding_block_cached__dense_activation_relu__prompt'

def setup_inputs():

    _w = (lambda a: (lambda t: t.to(torch.bfloat16) if t.is_floating_point() else t)(torch.as_tensor(a)))
    def _A_setup():
        B, Sq, D = 1, 2048, 1024
        Hq, Hkv, Sk, Dh = 32, 4, 2048, 128
        assert Hq % Hkv == 0, (Hq, Hkv)
        return {
            "x": _w((lambda *s: torch.randn(*s, dtype=torch.bfloat16) * 0.05)(B, Sq, D)),
            "k_cache": _w((lambda *s: torch.randn(*s, dtype=torch.bfloat16) * 0.8)(B, Hkv, Sk, Dh)),
            "v_cache": _w((lambda *s: torch.randn(*s, dtype=torch.bfloat16) * 0.2)(B, Hkv, Sk, Dh)),
            "wq": _w((lambda *s: torch.randn(*s, dtype=torch.bfloat16) * 0.8)(D, Hq * Dh) * (D ** -0.5)),
            "wo": _w((lambda *s: torch.randn(*s, dtype=torch.bfloat16) * 0.2)(Hq * Dh, D) * ((Hq * Dh) ** -0.5)),
        }
    _A_in = _A_setup()

    def _B_setup():
        B, S, D, Dff = 1, 2048, 1024, 3584
        return {
            "x": _w((lambda *s: torch.randn(*s, dtype=torch.bfloat16) * 0.05)(B, S, D)),
            "w1": _w((lambda *s: torch.randn(*s, dtype=torch.bfloat16) * 0.1)(D, Dff)),
            "w2": _w((lambda *s: torch.randn(*s, dtype=torch.bfloat16) * 0.1)(Dff, D)),
        }
    _B_in = _B_setup()

    return {
        "A_x": _A_in["x"],
        "A_k_cache": _A_in["k_cache"],
        "A_v_cache": _A_in["v_cache"],
        "A_wq": _A_in["wq"],
        "A_wo": _A_in["wo"],
        "B_x": _B_in["x"],
        "B_w1": _B_in["w1"],
        "B_w2": _B_in["w2"],
    }

def reference(A_x, A_k_cache, A_v_cache, A_wq, A_wo, B_x, B_w1, B_w2):
    def _A_ref(x, k_cache, v_cache, wq, wo):
        B, Sq, D = x.shape
        Hq, Dh = 32, 128
        Hkv, Sk = k_cache.shape[1], k_cache.shape[2]
        W = min(4096, max(256, Sk // 4))
        rep = Hq // Hkv
        q = (lambda x, *d: x.permute(*d))((x @ wq).reshape(B, Sq, Hq, Dh), 0, 2, 1, 3)
        k = (lambda x, n, axis: torch.repeat_interleave(x, n, dim=axis))(k_cache[:, :, Sk - W:, :], rep, axis=1)
        v = (lambda x, n, axis: torch.repeat_interleave(x, n, dim=axis))(v_cache[:, :, Sk - W:, :], rep, axis=1)
        scores = torch.einsum("bhqd,bhkd->bhqk", q, k) * (Dh ** -0.5)
        p = _softmax(scores, axis=-1)
        o = torch.einsum("bhqk,bhkd->bhqd", p, v)
        return (lambda x, *d: x.permute(*d))(o, 0, 2, 1, 3).reshape(B, Sq, Hq * Dh) @ wo

    def _B_ref(x, w1, w2):
        h = torch.einsum("bsd,df->bsf", x, w1)
        zero = torch.zeros_like(h)
        h = torch.maximum(h, zero)
        return torch.einsum("bsf,fd->bsd", h, w2)

    x = A_x
    xn = _layernorm(x, axis=-1)
    s = _A_ref(xn, A_k_cache, A_v_cache, A_wq, A_wo)
    g = _silu(_B_ref(xn, B_w1, B_w2))
    return x + s * g
```

```asm
; @launch kernel=ln_kernel grid=(512,1,1) block=(256,1,1) lds=0
; @launch kernel=gemm1_kernel grid=(240,1,1) block=(256,1,1) lds=131072
; @launch kernel=attn_kernel grid=(512,1,1) block=(256,1,1) lds=66560
; @launch kernel=gemm2_kernel grid=(256,1,1) block=(256,1,1) lds=131072
; @launch kernel=comb_kernel grid=(1024,1,1) block=(256,1,1) lds=0
.amdgcn_target "amdgcn-amd-amdhsa--gfx950"
.text
.globl ln_kernel
.p2align 8
.type ln_kernel,@function
ln_kernel:
    s_load_dwordx2 s[4:5], s[0:1], 0
    s_load_dwordx2 s[6:7], s[0:1], 80
    s_cmp_ge_u32 s2, 512
    s_cbranch_scc1 L_ln_end
    s_waitcnt lgkmcnt(0)
    s_mov_b32 s8, s4
    s_mov_b32 s9, s5
    s_mov_b32 s10, 0x400000
    s_mov_b32 s11, 0x00020000
    s_mov_b32 s12, s6
    s_mov_b32 s13, s7
    s_mov_b32 s14, 0x400000
    s_mov_b32 s15, 0x00020000
    v_lshrrev_b32 v1, 6, v0
    s_lshl_b32 s16, s2, 2
    v_add_u32 v1, s16, v1
    v_lshlrev_b32 v1, 11, v1
    v_and_b32 v2, 63, v0
    v_lshlrev_b32 v2, 4, v2
    v_add_u32 v1, v1, v2
    buffer_load_dwordx4 v[4:7], v1, s[8:11], 0 offen
    buffer_load_dwordx4 v[8:11], v1, s[8:11], 0 offen offset:1024
    s_waitcnt vmcnt(1)
    v_lshlrev_b32 v16, 16, v4
    v_and_b32 v17, 0xffff0000, v4
    v_lshlrev_b32 v18, 16, v5
    v_and_b32 v19, 0xffff0000, v5
    v_lshlrev_b32 v20, 16, v6
    v_and_b32 v21, 0xffff0000, v6
    v_lshlrev_b32 v22, 16, v7
    v_and_b32 v23, 0xffff0000, v7
    s_waitcnt vmcnt(0)
    v_lshlrev_b32 v24, 16, v8
    v_and_b32 v25, 0xffff0000, v8
    v_lshlrev_b32 v26, 16, v9
    v_and_b32 v27, 0xffff0000, v9
    v_lshlrev_b32 v28, 16, v10
    v_and_b32 v29, 0xffff0000, v10
    v_lshlrev_b32 v30, 16, v11
    v_and_b32 v31, 0xffff0000, v11
    v_add_f32 v32, v16, v17
    v_add_f32 v33, v18, v19
    v_add_f32 v32, v32, v20
    v_add_f32 v33, v33, v21
    v_add_f32 v32, v32, v22
    v_add_f32 v33, v33, v23
    v_add_f32 v32, v32, v24
    v_add_f32 v33, v33, v25
    v_add_f32 v32, v32, v26
    v_add_f32 v33, v33, v27
    v_add_f32 v32, v32, v28
    v_add_f32 v33, v33, v29
    v_add_f32 v32, v32, v30
    v_add_f32 v33, v33, v31
    v_add_f32 v32, v32, v33
    ds_swizzle_b32 v33, v32 offset:0x041f
    s_waitcnt lgkmcnt(0)
    v_add_f32 v32, v32, v33
    ds_swizzle_b32 v33, v32 offset:0x081f
    s_waitcnt lgkmcnt(0)
    v_add_f32 v32, v32, v33
    ds_swizzle_b32 v33, v32 offset:0x101f
    s_waitcnt lgkmcnt(0)
    v_add_f32 v32, v32, v33
    ds_swizzle_b32 v33, v32 offset:0x201f
    s_waitcnt lgkmcnt(0)
    v_add_f32 v32, v32, v33
    ds_swizzle_b32 v33, v32 offset:0x401f
    s_waitcnt lgkmcnt(0)
    v_add_f32 v32, v32, v33
    v_mov_b32 v33, v32
    s_nop 1
    v_permlane32_swap_b32 v32, v33
    v_add_f32 v32, v32, v33
    v_mul_f32 v32, 0x3a800000, v32
    v_mov_b32 v34, 0
    v_mov_b32 v35, 0
    v_sub_f32 v36, v16, v32
    v_fmac_f32 v34, v36, v36
    v_sub_f32 v36, v17, v32
    v_fmac_f32 v35, v36, v36
    v_sub_f32 v36, v18, v32
    v_fmac_f32 v34, v36, v36
    v_sub_f32 v36, v19, v32
    v_fmac_f32 v35, v36, v36
    v_sub_f32 v36, v20, v32
    v_fmac_f32 v34, v36, v36
    v_sub_f32 v36, v21, v32
    v_fmac_f32 v35, v36, v36
    v_sub_f32 v36, v22, v32
    v_fmac_f32 v34, v36, v36
    v_sub_f32 v36, v23, v32
    v_fmac_f32 v35, v36, v36
    v_sub_f32 v36, v24, v32
    v_fmac_f32 v34, v36, v36
    v_sub_f32 v36, v25, v32
    v_fmac_f32 v35, v36, v36
    v_sub_f32 v36, v26, v32
    v_fmac_f32 v34, v36, v36
    v_sub_f32 v36, v27, v32
    v_fmac_f32 v35, v36, v36
    v_sub_f32 v36, v28, v32
    v_fmac_f32 v34, v36, v36
    v_sub_f32 v36, v29, v32
    v_fmac_f32 v35, v36, v36
    v_sub_f32 v36, v30, v32
    v_fmac_f32 v34, v36, v36
    v_sub_f32 v36, v31, v32
    v_fmac_f32 v35, v36, v36
    v_add_f32 v34, v34, v35
    ds_swizzle_b32 v35, v34 offset:0x041f
    s_waitcnt lgkmcnt(0)
    v_add_f32 v34, v34, v35
    ds_swizzle_b32 v35, v34 offset:0x081f
    s_waitcnt lgkmcnt(0)
    v_add_f32 v34, v34, v35
    ds_swizzle_b32 v35, v34 offset:0x101f
    s_waitcnt lgkmcnt(0)
    v_add_f32 v34, v34, v35
    ds_swizzle_b32 v35, v34 offset:0x201f
    s_waitcnt lgkmcnt(0)
    v_add_f32 v34, v34, v35
    ds_swizzle_b32 v35, v34 offset:0x401f
    s_waitcnt lgkmcnt(0)
    v_add_f32 v34, v34, v35
    v_mov_b32 v35, v34
    s_nop 1
    v_permlane32_swap_b32 v34, v35
    v_add_f32 v34, v34, v35
    v_mul_f32 v34, 0x3a800000, v34
    v_cvt_pk_bf16_f32 v32, v32, v32
    v_lshlrev_b32 v32, 16, v32
    v_cvt_pk_bf16_f32 v34, v34, v34
    v_lshlrev_b32 v34, 16, v34
    v_add_f32 v34, 0x3727c5ac, v34
    v_cvt_pk_bf16_f32 v34, v34, v34
    v_lshlrev_b32 v34, 16, v34
    v_sqrt_f32 v34, v34
    s_nop 0
    v_cvt_pk_bf16_f32 v34, v34, v34
    v_lshlrev_b32 v34, 16, v34
    v_rcp_f32 v35, v34
    v_sub_f32 v16, v16, v32
    v_sub_f32 v17, v17, v32
    v_sub_f32 v18, v18, v32
    v_sub_f32 v19, v19, v32
    v_sub_f32 v20, v20, v32
    v_sub_f32 v21, v21, v32
    v_sub_f32 v22, v22, v32
    v_sub_f32 v23, v23, v32
    v_sub_f32 v24, v24, v32
    v_sub_f32 v25, v25, v32
    v_sub_f32 v26, v26, v32
    v_sub_f32 v27, v27, v32
    v_sub_f32 v28, v28, v32
    v_sub_f32 v29, v29, v32
    v_sub_f32 v30, v30, v32
    v_sub_f32 v31, v31, v32
    v_cvt_pk_bf16_f32 v40, v16, v17
    v_lshlrev_b32 v16, 16, v40
    v_and_b32 v17, 0xffff0000, v40
    v_cvt_pk_bf16_f32 v40, v18, v19
    v_lshlrev_b32 v18, 16, v40
    v_and_b32 v19, 0xffff0000, v40
    v_cvt_pk_bf16_f32 v40, v20, v21
    v_lshlrev_b32 v20, 16, v40
    v_and_b32 v21, 0xffff0000, v40
    v_cvt_pk_bf16_f32 v40, v22, v23
    v_lshlrev_b32 v22, 16, v40
    v_and_b32 v23, 0xffff0000, v40
    v_cvt_pk_bf16_f32 v40, v24, v25
    v_lshlrev_b32 v24, 16, v40
    v_and_b32 v25, 0xffff0000, v40
    v_cvt_pk_bf16_f32 v40, v26, v27
    v_lshlrev_b32 v26, 16, v40
    v_and_b32 v27, 0xffff0000, v40
    v_cvt_pk_bf16_f32 v40, v28, v29
    v_lshlrev_b32 v28, 16, v40
    v_and_b32 v29, 0xffff0000, v40
    v_cvt_pk_bf16_f32 v40, v30, v31
    v_lshlrev_b32 v30, 16, v40
    v_and_b32 v31, 0xffff0000, v40
    v_mul_f32 v48, v16, v35
    v_mul_f32 v49, v17, v35
    v_mul_f32 v50, v18, v35
    v_mul_f32 v51, v19, v35
    v_mul_f32 v52, v20, v35
    v_mul_f32 v53, v21, v35
    v_mul_f32 v54, v22, v35
    v_mul_f32 v55, v23, v35
    v_mul_f32 v56, v24, v35
    v_mul_f32 v57, v25, v35
    v_mul_f32 v58, v26, v35
    v_mul_f32 v59, v27, v35
    v_mul_f32 v60, v28, v35
    v_mul_f32 v61, v29, v35
    v_mul_f32 v62, v30, v35
    v_mul_f32 v63, v31, v35
    v_fma_f32 v16, -v48, v34, v16
    v_fma_f32 v17, -v49, v34, v17
    v_fma_f32 v18, -v50, v34, v18
    v_fma_f32 v19, -v51, v34, v19
    v_fma_f32 v20, -v52, v34, v20
    v_fma_f32 v21, -v53, v34, v21
    v_fma_f32 v22, -v54, v34, v22
    v_fma_f32 v23, -v55, v34, v23
    v_fma_f32 v24, -v56, v34, v24
    v_fma_f32 v25, -v57, v34, v25
    v_fma_f32 v26, -v58, v34, v26
    v_fma_f32 v27, -v59, v34, v27
    v_fma_f32 v28, -v60, v34, v28
    v_fma_f32 v29, -v61, v34, v29
    v_fma_f32 v30, -v62, v34, v30
    v_fma_f32 v31, -v63, v34, v31
    v_fmac_f32 v48, v16, v35
    v_fmac_f32 v49, v17, v35
    v_fmac_f32 v50, v18, v35
    v_fmac_f32 v51, v19, v35
    v_fmac_f32 v52, v20, v35
    v_fmac_f32 v53, v21, v35
    v_fmac_f32 v54, v22, v35
    v_fmac_f32 v55, v23, v35
    v_fmac_f32 v56, v24, v35
    v_fmac_f32 v57, v25, v35
    v_fmac_f32 v58, v26, v35
    v_fmac_f32 v59, v27, v35
    v_fmac_f32 v60, v28, v35
    v_fmac_f32 v61, v29, v35
    v_fmac_f32 v62, v30, v35
    v_fmac_f32 v63, v31, v35
    v_cvt_pk_bf16_f32 v4, v48, v49
    v_cvt_pk_bf16_f32 v5, v50, v51
    v_cvt_pk_bf16_f32 v6, v52, v53
    v_cvt_pk_bf16_f32 v7, v54, v55
    v_cvt_pk_bf16_f32 v8, v56, v57
    v_cvt_pk_bf16_f32 v9, v58, v59
    v_cvt_pk_bf16_f32 v10, v60, v61
    v_cvt_pk_bf16_f32 v11, v62, v63
    buffer_store_dwordx4 v[4:7], v1, s[12:15], 0 offen
    buffer_store_dwordx4 v[8:11], v1, s[12:15], 0 offen offset:1024
L_ln_end:
    s_endpgm
.section .rodata,"a"
.p2align 6
.amdhsa_kernel ln_kernel
  .amdhsa_next_free_vgpr 64
  .amdhsa_next_free_sgpr 17
  .amdhsa_accum_offset 64
  .amdhsa_group_segment_fixed_size 0
  .amdhsa_kernarg_size 88
  .amdhsa_user_sgpr_count 2
  .amdhsa_user_sgpr_kernarg_segment_ptr 1
  .amdhsa_system_sgpr_workgroup_id_x 1
.end_amdhsa_kernel
.text
.globl gemm1_kernel
.p2align 8
.type gemm1_kernel,@function
gemm1_kernel:
    s_load_dwordx2 s[32:33], s[0:1], 24
    s_load_dwordx2 s[34:35], s[0:1], 48
    s_load_dwordx2 s[36:37], s[0:1], 80
    s_cmp_ge_u32 s2, 240
    s_cbranch_scc1 L_g1_end
    s_and_b32 s40, s2, 7
    s_lshr_b32 s41, s2, 3
    s_mul_i32 s40, s40, 30
    s_add_u32 s40, s40, s41
    s_and_b32 s41, s40, 7
    s_lshr_b32 s42, s40, 3
    s_lshl_b32 s41, s41, 8
    s_lshl_b32 s43, s42, 8
    s_waitcnt lgkmcnt(0)
    s_cmp_lt_u32 s42, 16
    s_cselect_b64 s[44:45], s[32:33], s[34:35]
    s_movk_i32 s46, 8192
    s_movk_i32 s47, 7168
    s_cselect_b32 s17, s46, s47
    s_mov_b32 s26, s17
    s_sub_u32 s48, s43, 4096
    s_cselect_b32 s43, s43, s48
    s_mov_b32 s46, 0x80008000
    s_cselect_b32 s28, s46, 0
    s_mov_b32 s46, 0x400000
    s_mov_b32 s47, 0x1400000
    s_cselect_b32 s46, s46, s47
    s_mov_b32 s4, s36
    s_mov_b32 s5, s37
    s_mov_b32 s6, 0x400000
    s_mov_b32 s7, 0x00020000
    s_mov_b32 s8, s44
    s_mov_b32 s9, s45
    s_lshl_b32 s10, s17, 10
    s_mov_b32 s11, 0x00020000
    s_add_u32 s12, s36, s46
    s_addc_u32 s13, s37, 0
    s_lshl_b32 s14, s26, 11
    s_mov_b32 s15, 0x00020000
    s_movk_i32 s16, 2048
    s_lshl_b32 s18, s41, 11
    s_lshl_b32 s19, s43, 1
    s_mul_i32 s27, s41, s26
    s_add_u32 s27, s27, s19
    s_movk_i32 s20, 7
    v_lshrrev_b32 v1, 6, v0
    s_nop 0
    v_readfirstlane_b32 s23, v1
    v_and_b32 v2, 63, v0
    s_nop 1
    s_lshl_b32 s21, s23, 10
    s_lshr_b32 s29, s23, 1
    s_mul_i32 s24, s29, 128
    s_and_b32 s29, s23, 1
    s_mul_i32 s25, s29, 128
    v_lshrrev_b32 v3, 3, v2
    s_lshl_b32 s29, s23, 3
    v_add_u32 v3, s29, v3
    v_lshrrev_b32 v4, 4, v2
    s_and_b32 s29, s23, 1
    s_lshl_b32 s29, s29, 2
    v_or_b32 v4, s29, v4
    v_and_b32 v5, 7, v2
    v_xor_b32 v5, v5, v4
    v_lshlrev_b32 v5, 4, v5
    v_mad_u32_u24 v18, v3, s16, v5
    s_lshl_b32 s29, s16, 5
    v_add_u32 v19, s29, v18
    v_add_u32 v20, s29, v19
    v_add_u32 v21, s29, v20
    v_add_u32 v22, s29, v21
    v_add_u32 v23, s29, v22
    v_add_u32 v24, s29, v23
    v_add_u32 v25, s29, v24
    v_lshrrev_b32 v3, 5, v2
    s_mul_i32 s29, s23, 2
    v_add_u32 v3, s29, v3
    v_and_b32 v5, 31, v2
    v_add_u32 v4, 0, v3
    v_and_b32 v6, 3, v4
    v_lshlrev_b32 v6, 2, v6
    v_lshrrev_b32 v7, 2, v4
    v_and_b32 v7, 2, v7
    v_or_b32 v6, v6, v7
    v_xor_b32 v6, v5, v6
    v_lshlrev_b32 v6, 4, v6
    v_mad_u32_u24 v26, v4, s17, v6
    v_add_u32 v4, 8, v3
    v_and_b32 v6, 3, v4
    v_lshlrev_b32 v6, 2, v6
    v_lshrrev_b32 v7, 2, v4
    v_and_b32 v7, 2, v7
    v_or_b32 v6, v6, v7
    v_xor_b32 v6, v5, v6
    v_lshlrev_b32 v6, 4, v6
    v_mad_u32_u24 v27, v4, s17, v6
    v_add_u32 v4, 16, v3
    v_and_b32 v6, 3, v4
    v_lshlrev_b32 v6, 2, v6
    v_lshrrev_b32 v7, 2, v4
    v_and_b32 v7, 2, v7
    v_or_b32 v6, v6, v7
    v_xor_b32 v6, v5, v6
    v_lshlrev_b32 v6, 4, v6
    v_mad_u32_u24 v28, v4, s17, v6
    v_add_u32 v4, 24, v3
    v_and_b32 v6, 3, v4
    v_lshlrev_b32 v6, 2, v6
    v_lshrrev_b32 v7, 2, v4
    v_and_b32 v7, 2, v7
    v_or_b32 v6, v6, v7
    v_xor_b32 v6, v5, v6
    v_lshlrev_b32 v6, 4, v6
    v_mad_u32_u24 v29, v4, s17, v6
    v_add_u32 v4, 32, v3
    v_and_b32 v6, 3, v4
    v_lshlrev_b32 v6, 2, v6
    v_lshrrev_b32 v7, 2, v4
    v_and_b32 v7, 2, v7
    v_or_b32 v6, v6, v7
    v_xor_b32 v6, v5, v6
    v_lshlrev_b32 v6, 4, v6
    v_mad_u32_u24 v30, v4, s17, v6
    v_add_u32 v4, 40, v3
    v_and_b32 v6, 3, v4
    v_lshlrev_b32 v6, 2, v6
    v_lshrrev_b32 v7, 2, v4
    v_and_b32 v7, 2, v7
    v_or_b32 v6, v6, v7
    v_xor_b32 v6, v5, v6
    v_lshlrev_b32 v6, 4, v6
    v_mad_u32_u24 v31, v4, s17, v6
    v_add_u32 v4, 48, v3
    v_and_b32 v6, 3, v4
    v_lshlrev_b32 v6, 2, v6
    v_lshrrev_b32 v7, 2, v4
    v_and_b32 v7, 2, v7
    v_or_b32 v6, v6, v7
    v_xor_b32 v6, v5, v6
    v_lshlrev_b32 v6, 4, v6
    v_mad_u32_u24 v32, v4, s17, v6
    v_add_u32 v4, 56, v3
    v_and_b32 v6, 3, v4
    v_lshlrev_b32 v6, 2, v6
    v_lshrrev_b32 v7, 2, v4
    v_and_b32 v7, 2, v7
    v_or_b32 v6, v6, v7
    v_xor_b32 v6, v5, v6
    v_lshlrev_b32 v6, 4, v6
    v_mad_u32_u24 v33, v4, s17, v6
    s_lshl_b32 s22, s17, 6
    v_and_b32 v3, 15, v2
    v_add_u32 v3, s24, v3
    v_lshlrev_b32 v3, 7, v3
    v_lshrrev_b32 v4, 4, v2
    v_bfe_u32 v5, v2, 1, 3
    v_xor_b32 v4, v4, v5
    v_xor_b32 v5, 0, v4
    v_lshl_add_u32 v8, v5, 4, v3
    v_xor_b32 v5, 4, v4
    v_lshl_add_u32 v9, v5, 4, v3
    v_lshrrev_b32 v3, 4, v2
    v_bfe_u32 v4, v2, 2, 2
    v_lshl_add_u32 v5, v3, 3, v4
    v_lshlrev_b32 v5, 9, v5
    v_and_b32 v6, 1, v2
    v_lshl_add_u32 v5, v6, 3, v5
    v_add_u32 v5, 0x10000, v5
    v_lshlrev_b32 v4, 2, v4
    v_and_b32 v3, 1, v3
    v_lshl_or_b32 v4, v3, 1, v4
    v_bfe_u32 v6, v2, 1, 1
    s_lshr_b32 s29, s25, 3
    s_add_u32 s30, s29, 0
    v_xor_b32 v7, s30, v4
    v_add_u32 v7, v7, v6
    v_lshl_add_u32 v10, v7, 4, v5
    s_add_u32 s30, s29, 2
    v_xor_b32 v7, s30, v4
    v_add_u32 v7, v7, v6
    v_lshl_add_u32 v11, v7, 4, v5
    s_add_u32 s30, s29, 4
    v_xor_b32 v7, s30, v4
    v_add_u32 v7, v7, v6
    v_lshl_add_u32 v12, v7, 4, v5
    s_add_u32 s30, s29, 6
    v_xor_b32 v7, s30, v4
    v_add_u32 v7, v7, v6
    v_lshl_add_u32 v13, v7, 4, v5
    s_add_u32 s30, s29, 8
    v_xor_b32 v7, s30, v4
    v_add_u32 v7, v7, v6
    v_lshl_add_u32 v14, v7, 4, v5
    s_add_u32 s30, s29, 10
    v_xor_b32 v7, s30, v4
    v_add_u32 v7, v7, v6
    v_lshl_add_u32 v15, v7, 4, v5
    s_add_u32 s30, s29, 12
    v_xor_b32 v7, s30, v4
    v_add_u32 v7, v7, v6
    v_lshl_add_u32 v16, v7, 4, v5
    s_add_u32 s30, s29, 14
    v_xor_b32 v7, s30, v4
    v_add_u32 v7, v7, v6
    v_lshl_add_u32 v17, v7, 4, v5
    v_and_b32 v3, 15, v2
    v_add_u32 v3, s24, v3
    v_bfe_u32 v4, v2, 4, 1
    v_lshlrev_b32 v4, 5, v4
    v_bfe_u32 v5, v2, 5, 1
    v_lshl_add_u32 v4, v5, 4, v4
    s_lshl_b32 s29, s25, 1
    v_add_u32 v4, s29, v4
    v_mad_u32_u24 v34, v3, s26, v4
    s_lshl_b32 s29, s26, 4
    v_add_u32 v35, s29, v34
    v_add_u32 v36, s29, v35
    v_add_u32 v37, s29, v36
    v_add_u32 v38, s29, v37
    v_add_u32 v39, s29, v38
    v_add_u32 v40, s29, v39
    v_add_u32 v41, s29, v40
    s_add_u32 m0, s21, 0x0
    s_nop 0
    buffer_load_dwordx4 v18, s[4:7], s18 offen lds
    s_add_u32 m0, s21, 0x1000
    s_nop 0
    buffer_load_dwordx4 v19, s[4:7], s18 offen lds
    s_add_u32 m0, s21, 0x2000
    s_nop 0
    buffer_load_dwordx4 v20, s[4:7], s18 offen lds
    s_add_u32 m0, s21, 0x3000
    s_nop 0
    buffer_load_dwordx4 v21, s[4:7], s18 offen lds
    s_add_u32 m0, s21, 0x4000
    s_nop 0
    buffer_load_dwordx4 v22, s[4:7], s18 offen lds
    s_add_u32 m0, s21, 0x5000
    s_nop 0
    buffer_load_dwordx4 v23, s[4:7], s18 offen lds
    s_add_u32 m0, s21, 0x6000
    s_nop 0
    buffer_load_dwordx4 v24, s[4:7], s18 offen lds
    s_add_u32 m0, s21, 0x7000
    s_nop 0
    buffer_load_dwordx4 v25, s[4:7], s18 offen lds
    s_add_u32 m0, s21, 0x10000
    s_nop 0
    buffer_load_dwordx4 v26, s[8:11], s19 offen lds
    s_add_u32 m0, s21, 0x11000
    s_nop 0
    buffer_load_dwordx4 v27, s[8:11], s19 offen lds
    s_add_u32 m0, s21, 0x12000
    s_nop 0
    buffer_load_dwordx4 v28, s[8:11], s19 offen lds
    s_add_u32 m0, s21, 0x13000
    s_nop 0
    buffer_load_dwordx4 v29, s[8:11], s19 offen lds
    s_add_u32 m0, s21, 0x14000
    s_nop 0
    buffer_load_dwordx4 v30, s[8:11], s19 offen lds
    s_add_u32 m0, s21, 0x15000
    s_nop 0
    buffer_load_dwordx4 v31, s[8:11], s19 offen lds
    s_add_u32 m0, s21, 0x16000
    s_nop 0
    buffer_load_dwordx4 v32, s[8:11], s19 offen lds
    s_add_u32 m0, s21, 0x17000
    s_nop 0
    buffer_load_dwordx4 v33, s[8:11], s19 offen lds
    s_add_u32 s18, s18, 128
    s_add_u32 s19, s19, s22
    s_waitcnt lgkmcnt(0)
    s_waitcnt vmcnt(0)
    s_barrier
    s_add_u32 m0, s21, 0x8000
    ds_read_b64_tr_b16 v[108:109], v10 offset:0
    buffer_load_dwordx4 v18, s[4:7], s18 offen lds
    s_add_u32 m0, s21, 0x9000
    ds_read_b64_tr_b16 v[110:111], v10 offset:2048
    buffer_load_dwordx4 v19, s[4:7], s18 offen lds
    s_add_u32 m0, s21, 0xa000
    ds_read_b128 v[44:47], v8 offset:0
    buffer_load_dwordx4 v20, s[4:7], s18 offen lds
    s_add_u32 m0, s21, 0xb000
    ds_read_b128 v[48:51], v8 offset:2048
    buffer_load_dwordx4 v21, s[4:7], s18 offen lds
    s_add_u32 m0, s21, 0xc000
    ds_read_b128 v[52:55], v8 offset:4096
    buffer_load_dwordx4 v22, s[4:7], s18 offen lds
    s_add_u32 m0, s21, 0xd000
    ds_read_b128 v[56:59], v8 offset:6144
    buffer_load_dwordx4 v23, s[4:7], s18 offen lds
    s_add_u32 m0, s21, 0xe000
    ds_read_b128 v[60:63], v8 offset:8192
    buffer_load_dwordx4 v24, s[4:7], s18 offen lds
    s_add_u32 m0, s21, 0xf000
    ds_read_b128 v[64:67], v8 offset:10240
    buffer_load_dwordx4 v25, s[4:7], s18 offen lds
    s_add_u32 m0, s21, 0x18000
    ds_read_b128 v[68:71], v8 offset:12288
    buffer_load_dwordx4 v26, s[8:11], s19 offen lds
    s_add_u32 m0, s21, 0x19000
    ds_read_b128 v[72:75], v8 offset:14336
    buffer_load_dwordx4 v27, s[8:11], s19 offen lds
    s_add_u32 m0, s21, 0x1a000
    ds_read_b64_tr_b16 v[112:113], v11 offset:0
    buffer_load_dwordx4 v28, s[8:11], s19 offen lds
    s_add_u32 m0, s21, 0x1b000
    ds_read_b64_tr_b16 v[114:115], v11 offset:2048
    buffer_load_dwordx4 v29, s[8:11], s19 offen lds
    s_add_u32 m0, s21, 0x1c000
    ds_read_b64_tr_b16 v[116:117], v12 offset:0
    buffer_load_dwordx4 v30, s[8:11], s19 offen lds
    s_add_u32 m0, s21, 0x1d000
    ds_read_b64_tr_b16 v[118:119], v12 offset:2048
    buffer_load_dwordx4 v31, s[8:11], s19 offen lds
    s_add_u32 m0, s21, 0x1e000
    ds_read_b64_tr_b16 v[120:121], v13 offset:0
    buffer_load_dwordx4 v32, s[8:11], s19 offen lds
    s_add_u32 m0, s21, 0x1f000
    ds_read_b64_tr_b16 v[122:123], v13 offset:2048
    buffer_load_dwordx4 v33, s[8:11], s19 offen lds
    s_add_u32 s18, s18, 128
    s_add_u32 s19, s19, s22
    ds_read_b64_tr_b16 v[124:125], v14 offset:0
    ds_read_b64_tr_b16 v[126:127], v14 offset:2048
    ds_read_b64_tr_b16 v[128:129], v15 offset:0
    ds_read_b64_tr_b16 v[130:131], v15 offset:2048
    ds_read_b64_tr_b16 v[132:133], v16 offset:0
    ds_read_b64_tr_b16 v[134:135], v16 offset:2048
    ds_read_b64_tr_b16 v[136:137], v17 offset:0
    ds_read_b64_tr_b16 v[138:139], v17 offset:2048
    s_waitcnt lgkmcnt(15)
    v_mfma_f32_16x16x32_bf16 a[0:3], v[108:111], v[44:47], 0
    ds_read_b64_tr_b16 v[140:141], v10 offset:16384
    v_mfma_f32_16x16x32_bf16 a[4:7], v[108:111], v[48:51], 0
    ds_read_b64_tr_b16 v[142:143], v10 offset:18432
    v_mfma_f32_16x16x32_bf16 a[8:11], v[108:111], v[52:55], 0
    ds_read_b128 v[76:79], v9 offset:0
    v_mfma_f32_16x16x32_bf16 a[12:15], v[108:111], v[56:59], 0
    ds_read_b128 v[80:83], v9 offset:2048
    v_mfma_f32_16x16x32_bf16 a[16:19], v[108:111], v[60:63], 0
    ds_read_b128 v[84:87], v9 offset:4096
    v_mfma_f32_16x16x32_bf16 a[20:23], v[108:111], v[64:67], 0
    ds_read_b128 v[88:91], v9 offset:6144
    v_mfma_f32_16x16x32_bf16 a[24:27], v[108:111], v[68:71], 0
    ds_read_b128 v[92:95], v9 offset:8192
    s_waitcnt lgkmcnt(15)
    v_mfma_f32_16x16x32_bf16 a[28:31], v[108:111], v[72:75], 0
    ds_read_b128 v[96:99], v9 offset:10240
    v_mfma_f32_16x16x32_bf16 a[32:35], v[112:115], v[44:47], 0
    ds_read_b128 v[100:103], v9 offset:12288
    v_mfma_f32_16x16x32_bf16 a[36:39], v[112:115], v[48:51], 0
    ds_read_b128 v[104:107], v9 offset:14336
    v_mfma_f32_16x16x32_bf16 a[40:43], v[112:115], v[52:55], 0
    ds_read_b64_tr_b16 v[144:145], v11 offset:16384
    v_mfma_f32_16x16x32_bf16 a[44:47], v[112:115], v[56:59], 0
    ds_read_b64_tr_b16 v[146:147], v11 offset:18432
    v_mfma_f32_16x16x32_bf16 a[48:51], v[112:115], v[60:63], 0
    ds_read_b64_tr_b16 v[148:149], v12 offset:16384
    v_mfma_f32_16x16x32_bf16 a[52:55], v[112:115], v[64:67], 0
    ds_read_b64_tr_b16 v[150:151], v12 offset:18432
    v_mfma_f32_16x16x32_bf16 a[56:59], v[112:115], v[68:71], 0
    ds_read_b64_tr_b16 v[152:153], v13 offset:16384
    v_mfma_f32_16x16x32_bf16 a[60:63], v[112:115], v[72:75], 0
    ds_read_b64_tr_b16 v[154:155], v13 offset:18432
    v_mfma_f32_16x16x32_bf16 a[64:67], v[116:119], v[44:47], 0
    ds_read_b64_tr_b16 v[156:157], v14 offset:16384
    v_mfma_f32_16x16x32_bf16 a[68:71], v[116:119], v[48:51], 0
    ds_read_b64_tr_b16 v[158:159], v14 offset:18432
    v_mfma_f32_16x16x32_bf16 a[72:75], v[116:119], v[52:55], 0
    ds_read_b64_tr_b16 v[160:161], v15 offset:16384
    v_mfma_f32_16x16x32_bf16 a[76:79], v[116:119], v[56:59], 0
    ds_read_b64_tr_b16 v[162:163], v15 offset:18432
    v_mfma_f32_16x16x32_bf16 a[80:83], v[116:119], v[60:63], 0
    ds_read_b64_tr_b16 v[164:165], v16 offset:16384
    v_mfma_f32_16x16x32_bf16 a[84:87], v[116:119], v[64:67], 0
    ds_read_b64_tr_b16 v[166:167], v16 offset:18432
    v_mfma_f32_16x16x32_bf16 a[88:91], v[116:119], v[68:71], 0
    ds_read_b64_tr_b16 v[168:169], v17 offset:16384
    v_mfma_f32_16x16x32_bf16 a[92:95], v[116:119], v[72:75], 0
    ds_read_b64_tr_b16 v[170:171], v17 offset:18432
    v_mfma_f32_16x16x32_bf16 a[96:99], v[120:123], v[44:47], 0
    v_mfma_f32_16x16x32_bf16 a[100:103], v[120:123], v[48:51], 0
    v_mfma_f32_16x16x32_bf16 a[104:107], v[120:123], v[52:55], 0
    v_mfma_f32_16x16x32_bf16 a[108:111], v[120:123], v[56:59], 0
    v_mfma_f32_16x16x32_bf16 a[112:115], v[120:123], v[60:63], 0
    v_mfma_f32_16x16x32_bf16 a[116:119], v[120:123], v[64:67], 0
    v_mfma_f32_16x16x32_bf16 a[120:123], v[120:123], v[68:71], 0
    v_mfma_f32_16x16x32_bf16 a[124:127], v[120:123], v[72:75], 0
    s_waitcnt lgkmcnt(15)
    v_mfma_f32_16x16x32_bf16 a[128:131], v[124:127], v[44:47], 0
    v_mfma_f32_16x16x32_bf16 a[132:135], v[124:127], v[48:51], 0
    v_mfma_f32_16x16x32_bf16 a[136:139], v[124:127], v[52:55], 0
    v_mfma_f32_16x16x32_bf16 a[140:143], v[124:127], v[56:59], 0
    v_mfma_f32_16x16x32_bf16 a[144:147], v[124:127], v[60:63], 0
    v_mfma_f32_16x16x32_bf16 a[148:151], v[124:127], v[64:67], 0
    v_mfma_f32_16x16x32_bf16 a[152:155], v[124:127], v[68:71], 0
    v_mfma_f32_16x16x32_bf16 a[156:159], v[124:127], v[72:75], 0
    v_mfma_f32_16x16x32_bf16 a[160:163], v[128:131], v[44:47], 0
    v_mfma_f32_16x16x32_bf16 a[164:167], v[128:131], v[48:51], 0
    v_mfma_f32_16x16x32_bf16 a[168:171], v[128:131], v[52:55], 0
    v_mfma_f32_16x16x32_bf16 a[172:175], v[128:131], v[56:59], 0
    v_mfma_f32_16x16x32_bf16 a[176:179], v[128:131], v[60:63], 0
    v_mfma_f32_16x16x32_bf16 a[180:183], v[128:131], v[64:67], 0
    v_mfma_f32_16x16x32_bf16 a[184:187], v[128:131], v[68:71], 0
    v_mfma_f32_16x16x32_bf16 a[188:191], v[128:131], v[72:75], 0
    v_mfma_f32_16x16x32_bf16 a[192:195], v[132:135], v[44:47], 0
    v_mfma_f32_16x16x32_bf16 a[196:199], v[132:135], v[48:51], 0
    v_mfma_f32_16x16x32_bf16 a[200:203], v[132:135], v[52:55], 0
    v_mfma_f32_16x16x32_bf16 a[204:207], v[132:135], v[56:59], 0
    v_mfma_f32_16x16x32_bf16 a[208:211], v[132:135], v[60:63], 0
    v_mfma_f32_16x16x32_bf16 a[212:215], v[132:135], v[64:67], 0
    v_mfma_f32_16x16x32_bf16 a[216:219], v[132:135], v[68:71], 0
    v_mfma_f32_16x16x32_bf16 a[220:223], v[132:135], v[72:75], 0
    v_mfma_f32_16x16x32_bf16 a[224:227], v[136:139], v[44:47], 0
    v_mfma_f32_16x16x32_bf16 a[228:231], v[136:139], v[48:51], 0
    v_mfma_f32_16x16x32_bf16 a[232:235], v[136:139], v[52:55], 0
    v_mfma_f32_16x16x32_bf16 a[236:239], v[136:139], v[56:59], 0
    v_mfma_f32_16x16x32_bf16 a[240:243], v[136:139], v[60:63], 0
    v_mfma_f32_16x16x32_bf16 a[244:247], v[136:139], v[64:67], 0
    v_mfma_f32_16x16x32_bf16 a[248:251], v[136:139], v[68:71], 0
    v_mfma_f32_16x16x32_bf16 a[252:255], v[136:139], v[72:75], 0
    v_mfma_f32_16x16x32_bf16 a[0:3], v[140:143], v[76:79], a[0:3]
    v_mfma_f32_16x16x32_bf16 a[4:7], v[140:143], v[80:83], a[4:7]
    v_mfma_f32_16x16x32_bf16 a[8:11], v[140:143], v[84:87], a[8:11]
    v_mfma_f32_16x16x32_bf16 a[12:15], v[140:143], v[88:91], a[12:15]
    s_waitcnt lgkmcnt(0)
    s_waitcnt vmcnt(0)
    s_barrier
    v_mfma_f32_16x16x32_bf16 a[16:19], v[140:143], v[92:95], a[16:19]
    s_add_u32 m0, s21, 0x0
    v_mfma_f32_16x16x32_bf16 a[20:23], v[140:143], v[96:99], a[20:23]
    ds_read_b64_tr_b16 v[108:109], v10 offset:32768
    v_mfma_f32_16x16x32_bf16 a[24:27], v[140:143], v[100:103], a[24:27]
    buffer_load_dwordx4 v18, s[4:7], s18 offen lds
    v_mfma_f32_16x16x32_bf16 a[28:31], v[140:143], v[104:107], a[28:31]
    s_add_u32 m0, s21, 0x1000
    v_mfma_f32_16x16x32_bf16 a[32:35], v[144:147], v[76:79], a[32:35]
    ds_read_b64_tr_b16 v[110:111], v10 offset:34816
    v_mfma_f32_16x16x32_bf16 a[36:39], v[144:147], v[80:83], a[36:39]
    buffer_load_dwordx4 v19, s[4:7], s18 offen lds
    v_mfma_f32_16x16x32_bf16 a[40:43], v[144:147], v[84:87], a[40:43]
    s_add_u32 m0, s21, 0x2000
    v_mfma_f32_16x16x32_bf16 a[44:47], v[144:147], v[88:91], a[44:47]
    ds_read_b128 v[44:47], v8 offset:32768
    v_mfma_f32_16x16x32_bf16 a[48:51], v[144:147], v[92:95], a[48:51]
    buffer_load_dwordx4 v20, s[4:7], s18 offen lds
    v_mfma_f32_16x16x32_bf16 a[52:55], v[144:147], v[96:99], a[52:55]
    s_add_u32 m0, s21, 0x3000
    v_mfma_f32_16x16x32_bf16 a[56:59], v[144:147], v[100:103], a[56:59]
    ds_read_b128 v[48:51], v8 offset:34816
    v_mfma_f32_16x16x32_bf16 a[60:63], v[144:147], v[104:107], a[60:63]
    buffer_load_dwordx4 v21, s[4:7], s18 offen lds
    v_mfma_f32_16x16x32_bf16 a[64:67], v[148:151], v[76:79], a[64:67]
    s_add_u32 m0, s21, 0x4000
    v_mfma_f32_16x16x32_bf16 a[68:71], v[148:151], v[80:83], a[68:71]
    ds_read_b128 v[52:55], v8 offset:36864
    v_mfma_f32_16x16x32_bf16 a[72:75], v[148:151], v[84:87], a[72:75]
    buffer_load_dwordx4 v22, s[4:7], s18 offen lds
    v_mfma_f32_16x16x32_bf16 a[76:79], v[148:151], v[88:91], a[76:79]
    s_add_u32 m0, s21, 0x5000
    v_mfma_f32_16x16x32_bf16 a[80:83], v[148:151], v[92:95], a[80:83]
    ds_read_b128 v[56:59], v8 offset:38912
    v_mfma_f32_16x16x32_bf16 a[84:87], v[148:151], v[96:99], a[84:87]
    buffer_load_dwordx4 v23, s[4:7], s18 offen lds
    v_mfma_f32_16x16x32_bf16 a[88:91], v[148:151], v[100:103], a[88:91]
    s_add_u32 m0, s21, 0x6000
    v_mfma_f32_16x16x32_bf16 a[92:95], v[148:151], v[104:107], a[92:95]
    ds_read_b128 v[60:63], v8 offset:40960
    v_mfma_f32_16x16x32_bf16 a[96:99], v[152:155], v[76:79], a[96:99]
    buffer_load_dwordx4 v24, s[4:7], s18 offen lds
    v_mfma_f32_16x16x32_bf16 a[100:103], v[152:155], v[80:83], a[100:103]
    s_add_u32 m0, s21, 0x7000
    v_mfma_f32_16x16x32_bf16 a[104:107], v[152:155], v[84:87], a[104:107]
    ds_read_b128 v[64:67], v8 offset:43008
    v_mfma_f32_16x16x32_bf16 a[108:111], v[152:155], v[88:91], a[108:111]
    buffer_load_dwordx4 v25, s[4:7], s18 offen lds
    v_mfma_f32_16x16x32_bf16 a[112:115], v[152:155], v[92:95], a[112:115]
    s_add_u32 m0, s21, 0x10000
    v_mfma_f32_16x16x32_bf16 a[116:119], v[152:155], v[96:99], a[116:119]
    ds_read_b128 v[68:71], v8 offset:45056
    v_mfma_f32_16x16x32_bf16 a[120:123], v[152:155], v[100:103], a[120:123]
    buffer_load_dwordx4 v26, s[8:11], s19 offen lds
    v_mfma_f32_16x16x32_bf16 a[124:127], v[152:155], v[104:107], a[124:127]
    s_add_u32 m0, s21, 0x11000
    v_mfma_f32_16x16x32_bf16 a[128:131], v[156:159], v[76:79], a[128:131]
    ds_read_b128 v[72:75], v8 offset:47104
    v_mfma_f32_16x16x32_bf16 a[132:135], v[156:159], v[80:83], a[132:135]
    buffer_load_dwordx4 v27, s[8:11], s19 offen lds
    v_mfma_f32_16x16x32_bf16 a[136:139], v[156:159], v[84:87], a[136:139]
    s_add_u32 m0, s21, 0x12000
    v_mfma_f32_16x16x32_bf16 a[140:143], v[156:159], v[88:91], a[140:143]
    ds_read_b64_tr_b16 v[112:113], v11 offset:32768
    v_mfma_f32_16x16x32_bf16 a[144:147], v[156:159], v[92:95], a[144:147]
    buffer_load_dwordx4 v28, s[8:11], s19 offen lds
    v_mfma_f32_16x16x32_bf16 a[148:151], v[156:159], v[96:99], a[148:151]
    s_add_u32 m0, s21, 0x13000
    v_mfma_f32_16x16x32_bf16 a[152:155], v[156:159], v[100:103], a[152:155]
    ds_read_b64_tr_b16 v[114:115], v11 offset:34816
    v_mfma_f32_16x16x32_bf16 a[156:159], v[156:159], v[104:107], a[156:159]
    buffer_load_dwordx4 v29, s[8:11], s19 offen lds
    v_mfma_f32_16x16x32_bf16 a[160:163], v[160:163], v[76:79], a[160:163]
    s_add_u32 m0, s21, 0x14000
    v_mfma_f32_16x16x32_bf16 a[164:167], v[160:163], v[80:83], a[164:167]
    ds_read_b64_tr_b16 v[116:117], v12 offset:32768
    v_mfma_f32_16x16x32_bf16 a[168:171], v[160:163], v[84:87], a[168:171]
    buffer_load_dwordx4 v30, s[8:11], s19 offen lds
    v_mfma_f32_16x16x32_bf16 a[172:175], v[160:163], v[88:91], a[172:175]
    s_add_u32 m0, s21, 0x15000
    v_mfma_f32_16x16x32_bf16 a[176:179], v[160:163], v[92:95], a[176:179]
    ds_read_b64_tr_b16 v[118:119], v12 offset:34816
    v_mfma_f32_16x16x32_bf16 a[180:183], v[160:163], v[96:99], a[180:183]
    buffer_load_dwordx4 v31, s[8:11], s19 offen lds
    v_mfma_f32_16x16x32_bf16 a[184:187], v[160:163], v[100:103], a[184:187]
    s_add_u32 m0, s21, 0x16000
    v_mfma_f32_16x16x32_bf16 a[188:191], v[160:163], v[104:107], a[188:191]
    ds_read_b64_tr_b16 v[120:121], v13 offset:32768
    v_mfma_f32_16x16x32_bf16 a[192:195], v[164:167], v[76:79], a[192:195]
    buffer_load_dwordx4 v32, s[8:11], s19 offen lds
    v_mfma_f32_16x16x32_bf16 a[196:199], v[164:167], v[80:83], a[196:199]
    s_add_u32 m0, s21, 0x17000
    v_mfma_f32_16x16x32_bf16 a[200:203], v[164:167], v[84:87], a[200:203]
    ds_read_b64_tr_b16 v[122:123], v13 offset:34816
    v_mfma_f32_16x16x32_bf16 a[204:207], v[164:167], v[88:91], a[204:207]
    buffer_load_dwordx4 v33, s[8:11], s19 offen lds
    v_mfma_f32_16x16x32_bf16 a[208:211], v[164:167], v[92:95], a[208:211]
    s_add_u32 s18, s18, 128
    v_mfma_f32_16x16x32_bf16 a[212:215], v[164:167], v[96:99], a[212:215]
    s_add_u32 s19, s19, s22
    v_mfma_f32_16x16x32_bf16 a[216:219], v[164:167], v[100:103], a[216:219]
    ds_read_b64_tr_b16 v[124:125], v14 offset:32768
    v_mfma_f32_16x16x32_bf16 a[220:223], v[164:167], v[104:107], a[220:223]
    ds_read_b64_tr_b16 v[126:127], v14 offset:34816
    v_mfma_f32_16x16x32_bf16 a[224:227], v[168:171], v[76:79], a[224:227]
    ds_read_b64_tr_b16 v[128:129], v15 offset:32768
    v_mfma_f32_16x16x32_bf16 a[228:231], v[168:171], v[80:83], a[228:231]
    ds_read_b64_tr_b16 v[130:131], v15 offset:34816
    v_mfma_f32_16x16x32_bf16 a[232:235], v[168:171], v[84:87], a[232:235]
    ds_read_b64_tr_b16 v[132:133], v16 offset:32768
    v_mfma_f32_16x16x32_bf16 a[236:239], v[168:171], v[88:91], a[236:239]
    ds_read_b64_tr_b16 v[134:135], v16 offset:34816
    v_mfma_f32_16x16x32_bf16 a[240:243], v[168:171], v[92:95], a[240:243]
    ds_read_b64_tr_b16 v[136:137], v17 offset:32768
    v_mfma_f32_16x16x32_bf16 a[244:247], v[168:171], v[96:99], a[244:247]
    ds_read_b64_tr_b16 v[138:139], v17 offset:34816
    v_mfma_f32_16x16x32_bf16 a[248:251], v[168:171], v[100:103], a[248:251]
    v_mfma_f32_16x16x32_bf16 a[252:255], v[168:171], v[104:107], a[252:255]
    s_waitcnt lgkmcnt(15)
    v_mfma_f32_16x16x32_bf16 a[0:3], v[108:111], v[44:47], a[0:3]
    ds_read_b64_tr_b16 v[140:141], v10 offset:49152
    v_mfma_f32_16x16x32_bf16 a[4:7], v[108:111], v[48:51], a[4:7]
    ds_read_b64_tr_b16 v[142:143], v10 offset:51200
    v_mfma_f32_16x16x32_bf16 a[8:11], v[108:111], v[52:55], a[8:11]
    ds_read_b128 v[76:79], v9 offset:32768
    v_mfma_f32_16x16x32_bf16 a[12:15], v[108:111], v[56:59], a[12:15]
    ds_read_b128 v[80:83], v9 offset:34816
    v_mfma_f32_16x16x32_bf16 a[16:19], v[108:111], v[60:63], a[16:19]
    ds_read_b128 v[84:87], v9 offset:36864
    v_mfma_f32_16x16x32_bf16 a[20:23], v[108:111], v[64:67], a[20:23]
    ds_read_b128 v[88:91], v9 offset:38912
    v_mfma_f32_16x16x32_bf16 a[24:27], v[108:111], v[68:71], a[24:27]
    ds_read_b128 v[92:95], v9 offset:40960
    s_waitcnt lgkmcnt(15)
    v_mfma_f32_16x16x32_bf16 a[28:31], v[108:111], v[72:75], a[28:31]
    ds_read_b128 v[96:99], v9 offset:43008
    v_mfma_f32_16x16x32_bf16 a[32:35], v[112:115], v[44:47], a[32:35]
    ds_read_b128 v[100:103], v9 offset:45056
    v_mfma_f32_16x16x32_bf16 a[36:39], v[112:115], v[48:51], a[36:39]
    ds_read_b128 v[104:107], v9 offset:47104
    v_mfma_f32_16x16x32_bf16 a[40:43], v[112:115], v[52:55], a[40:43]
    ds_read_b64_tr_b16 v[144:145], v11 offset:49152
    v_mfma_f32_16x16x32_bf16 a[44:47], v[112:115], v[56:59], a[44:47]
    ds_read_b64_tr_b16 v[146:147], v11 offset:51200
    v_mfma_f32_16x16x32_bf16 a[48:51], v[112:115], v[60:63], a[48:51]
    ds_read_b64_tr_b16 v[148:149], v12 offset:49152
    v_mfma_f32_16x16x32_bf16 a[52:55], v[112:115], v[64:67], a[52:55]
    ds_read_b64_tr_b16 v[150:151], v12 offset:51200
    v_mfma_f32_16x16x32_bf16 a[56:59], v[112:115], v[68:71], a[56:59]
    ds_read_b64_tr_b16 v[152:153], v13 offset:49152
    v_mfma_f32_16x16x32_bf16 a[60:63], v[112:115], v[72:75], a[60:63]
    ds_read_b64_tr_b16 v[154:155], v13 offset:51200
    v_mfma_f32_16x16x32_bf16 a[64:67], v[116:119], v[44:47], a[64:67]
    ds_read_b64_tr_b16 v[156:157], v14 offset:49152
    v_mfma_f32_16x16x32_bf16 a[68:71], v[116:119], v[48:51], a[68:71]
    ds_read_b64_tr_b16 v[158:159], v14 offset:51200
    v_mfma_f32_16x16x32_bf16 a[72:75], v[116:119], v[52:55], a[72:75]
    ds_read_b64_tr_b16 v[160:161], v15 offset:49152
    v_mfma_f32_16x16x32_bf16 a[76:79], v[116:119], v[56:59], a[76:79]
    ds_read_b64_tr_b16 v[162:163], v15 offset:51200
    v_mfma_f32_16x16x32_bf16 a[80:83], v[116:119], v[60:63], a[80:83]
    ds_read_b64_tr_b16 v[164:165], v16 offset:49152
    v_mfma_f32_16x16x32_bf16 a[84:87], v[116:119], v[64:67], a[84:87]
    ds_read_b64_tr_b16 v[166:167], v16 offset:51200
    v_mfma_f32_16x16x32_bf16 a[88:91], v[116:119], v[68:71], a[88:91]
    ds_read_b64_tr_b16 v[168:169], v17 offset:49152
    v_mfma_f32_16x16x32_bf16 a[92:95], v[116:119], v[72:75], a[92:95]
    ds_read_b64_tr_b16 v[170:171], v17 offset:51200
    v_mfma_f32_16x16x32_bf16 a[96:99], v[120:123], v[44:47], a[96:99]
    v_mfma_f32_16x16x32_bf16 a[100:103], v[120:123], v[48:51], a[100:103]
    v_mfma_f32_16x16x32_bf16 a[104:107], v[120:123], v[52:55], a[104:107]
    v_mfma_f32_16x16x32_bf16 a[108:111], v[120:123], v[56:59], a[108:111]
    v_mfma_f32_16x16x32_bf16 a[112:115], v[120:123], v[60:63], a[112:115]
    v_mfma_f32_16x16x32_bf16 a[116:119], v[120:123], v[64:67], a[116:119]
    v_mfma_f32_16x16x32_bf16 a[120:123], v[120:123], v[68:71], a[120:123]
    v_mfma_f32_16x16x32_bf16 a[124:127], v[120:123], v[72:75], a[124:127]
    s_waitcnt lgkmcnt(15)
    v_mfma_f32_16x16x32_bf16 a[128:131], v[124:127], v[44:47], a[128:131]
    v_mfma_f32_16x16x32_bf16 a[132:135], v[124:127], v[48:51], a[132:135]
    v_mfma_f32_16x16x32_bf16 a[136:139], v[124:127], v[52:55], a[136:139]
    v_mfma_f32_16x16x32_bf16 a[140:143], v[124:127], v[56:59], a[140:143]
    v_mfma_f32_16x16x32_bf16 a[144:147], v[124:127], v[60:63], a[144:147]
    v_mfma_f32_16x16x32_bf16 a[148:151], v[124:127], v[64:67], a[148:151]
    v_mfma_f32_16x16x32_bf16 a[152:155], v[124:127], v[68:71], a[152:155]
    v_mfma_f32_16x16x32_bf16 a[156:159], v[124:127], v[72:75], a[156:159]
    v_mfma_f32_16x16x32_bf16 a[160:163], v[128:131], v[44:47], a[160:163]
    v_mfma_f32_16x16x32_bf16 a[164:167], v[128:131], v[48:51], a[164:167]
    v_mfma_f32_16x16x32_bf16 a[168:171], v[128:131], v[52:55], a[168:171]
    v_mfma_f32_16x16x32_bf16 a[172:175], v[128:131], v[56:59], a[172:175]
    v_mfma_f32_16x16x32_bf16 a[176:179], v[128:131], v[60:63], a[176:179]
    v_mfma_f32_16x16x32_bf16 a[180:183], v[128:131], v[64:67], a[180:183]
    v_mfma_f32_16x16x32_bf16 a[184:187], v[128:131], v[68:71], a[184:187]
    v_mfma_f32_16x16x32_bf16 a[188:191], v[128:131], v[72:75], a[188:191]
    v_mfma_f32_16x16x32_bf16 a[192:195], v[132:135], v[44:47], a[192:195]
    v_mfma_f32_16x16x32_bf16 a[196:199], v[132:135], v[48:51], a[196:199]
    v_mfma_f32_16x16x32_bf16 a[200:203], v[132:135], v[52:55], a[200:203]
    v_mfma_f32_16x16x32_bf16 a[204:207], v[132:135], v[56:59], a[204:207]
    v_mfma_f32_16x16x32_bf16 a[208:211], v[132:135], v[60:63], a[208:211]
    v_mfma_f32_16x16x32_bf16 a[212:215], v[132:135], v[64:67], a[212:215]
    v_mfma_f32_16x16x32_bf16 a[216:219], v[132:135], v[68:71], a[216:219]
    v_mfma_f32_16x16x32_bf16 a[220:223], v[132:135], v[72:75], a[220:223]
    v_mfma_f32_16x16x32_bf16 a[224:227], v[136:139], v[44:47], a[224:227]
    v_mfma_f32_16x16x32_bf16 a[228:231], v[136:139], v[48:51], a[228:231]
    v_mfma_f32_16x16x32_bf16 a[232:235], v[136:139], v[52:55], a[232:235]
    v_mfma_f32_16x16x32_bf16 a[236:239], v[136:139], v[56:59], a[236:239]
    v_mfma_f32_16x16x32_bf16 a[240:243], v[136:139], v[60:63], a[240:243]
    v_mfma_f32_16x16x32_bf16 a[244:247], v[136:139], v[64:67], a[244:247]
    v_mfma_f32_16x16x32_bf16 a[248:251], v[136:139], v[68:71], a[248:251]
    v_mfma_f32_16x16x32_bf16 a[252:255], v[136:139], v[72:75], a[252:255]
    v_mfma_f32_16x16x32_bf16 a[0:3], v[140:143], v[76:79], a[0:3]
    v_mfma_f32_16x16x32_bf16 a[4:7], v[140:143], v[80:83], a[4:7]
    v_mfma_f32_16x16x32_bf16 a[8:11], v[140:143], v[84:87], a[8:11]
    v_mfma_f32_16x16x32_bf16 a[12:15], v[140:143], v[88:91], a[12:15]
    s_waitcnt lgkmcnt(0)
    s_waitcnt vmcnt(0)
    s_barrier
    v_mfma_f32_16x16x32_bf16 a[16:19], v[140:143], v[92:95], a[16:19]
    s_add_u32 m0, s21, 0x8000
    v_mfma_f32_16x16x32_bf16 a[20:23], v[140:143], v[96:99], a[20:23]
    ds_read_b64_tr_b16 v[108:109], v10 offset:0
    v_mfma_f32_16x16x32_bf16 a[24:27], v[140:143], v[100:103], a[24:27]
    buffer_load_dwordx4 v18, s[4:7], s18 offen lds
    v_mfma_f32_16x16x32_bf16 a[28:31], v[140:143], v[104:107], a[28:31]
    s_add_u32 m0, s21, 0x9000
    v_mfma_f32_16x16x32_bf16 a[32:35], v[144:147], v[76:79], a[32:35]
    ds_read_b64_tr_b16 v[110:111], v10 offset:2048
    v_mfma_f32_16x16x32_bf16 a[36:39], v[144:147], v[80:83], a[36:39]
    buffer_load_dwordx4 v19, s[4:7], s18 offen lds
    v_mfma_f32_16x16x32_bf16 a[40:43], v[144:147], v[84:87], a[40:43]
    s_add_u32 m0, s21, 0xa000
    v_mfma_f32_16x16x32_bf16 a[44:47], v[144:147], v[88:91], a[44:47]
    ds_read_b128 v[44:47], v8 offset:0
    v_mfma_f32_16x16x32_bf16 a[48:51], v[144:147], v[92:95], a[48:51]
    buffer_load_dwordx4 v20, s[4:7], s18 offen lds
    v_mfma_f32_16x16x32_bf16 a[52:55], v[144:147], v[96:99], a[52:55]
    s_add_u32 m0, s21, 0xb000
    v_mfma_f32_16x16x32_bf16 a[56:59], v[144:147], v[100:103], a[56:59]
    ds_read_b128 v[48:51], v8 offset:2048
    v_mfma_f32_16x16x32_bf16 a[60:63], v[144:147], v[104:107], a[60:63]
    buffer_load_dwordx4 v21, s[4:7], s18 offen lds
    v_mfma_f32_16x16x32_bf16 a[64:67], v[148:151], v[76:79], a[64:67]
    s_add_u32 m0, s21, 0xc000
    v_mfma_f32_16x16x32_bf16 a[68:71], v[148:151], v[80:83], a[68:71]
    ds_read_b128 v[52:55], v8 offset:4096
    v_mfma_f32_16x16x32_bf16 a[72:75], v[148:151], v[84:87], a[72:75]
    buffer_load_dwordx4 v22, s[4:7], s18 offen lds
    v_mfma_f32_16x16x32_bf16 a[76:79], v[148:151], v[88:91], a[76:79]
    s_add_u32 m0, s21, 0xd000
    v_mfma_f32_16x16x32_bf16 a[80:83], v[148:151], v[92:95], a[80:83]
    ds_read_b128 v[56:59], v8 offset:6144
    v_mfma_f32_16x16x32_bf16 a[84:87], v[148:151], v[96:99], a[84:87]
    buffer_load_dwordx4 v23, s[4:7], s18 offen lds
    v_mfma_f32_16x16x32_bf16 a[88:91], v[148:151], v[100:103], a[88:91]
    s_add_u32 m0, s21, 0xe000
    v_mfma_f32_16x16x32_bf16 a[92:95], v[148:151], v[104:107], a[92:95]
    ds_read_b128 v[60:63], v8 offset:8192
    v_mfma_f32_16x16x32_bf16 a[96:99], v[152:155], v[76:79], a[96:99]
    buffer_load_dwordx4 v24, s[4:7], s18 offen lds
    v_mfma_f32_16x16x32_bf16 a[100:103], v[152:155], v[80:83], a[100:103]
    s_add_u32 m0, s21, 0xf000
    v_mfma_f32_16x16x32_bf16 a[104:107], v[152:155], v[84:87], a[104:107]
    ds_read_b128 v[64:67], v8 offset:10240
    v_mfma_f32_16x16x32_bf16 a[108:111], v[152:155], v[88:91], a[108:111]
    buffer_load_dwordx4 v25, s[4:7], s18 offen lds
    v_mfma_f32_16x16x32_bf16 a[112:115], v[152:155], v[92:95], a[112:115]
    s_add_u32 m0, s21, 0x18000
    v_mfma_f32_16x16x32_bf16 a[116:119], v[152:155], v[96:99], a[116:119]
    ds_read_b128 v[68:71], v8 offset:12288
    v_mfma_f32_16x16x32_bf16 a[120:123], v[152:155], v[100:103], a[120:123]
    buffer_load_dwordx4 v26, s[8:11], s19 offen lds
    v_mfma_f32_16x16x32_bf16 a[124:127], v[152:155], v[104:107], a[124:127]
    s_add_u32 m0, s21, 0x19000
    v_mfma_f32_16x16x32_bf16 a[128:131], v[156:159], v[76:79], a[128:131]
    ds_read_b128 v[72:75], v8 offset:14336
    v_mfma_f32_16x16x32_bf16 a[132:135], v[156:159], v[80:83], a[132:135]
    buffer_load_dwordx4 v27, s[8:11], s19 offen lds
    v_mfma_f32_16x16x32_bf16 a[136:139], v[156:159], v[84:87], a[136:139]
    s_add_u32 m0, s21, 0x1a000
    v_mfma_f32_16x16x32_bf16 a[140:143], v[156:159], v[88:91], a[140:143]
    ds_read_b64_tr_b16 v[112:113], v11 offset:0
    v_mfma_f32_16x16x32_bf16 a[144:147], v[156:159], v[92:95], a[144:147]
    buffer_load_dwordx4 v28, s[8:11], s19 offen lds
    v_mfma_f32_16x16x32_bf16 a[148:151], v[156:159], v[96:99], a[148:151]
    s_add_u32 m0, s21, 0x1b000
    v_mfma_f32_16x16x32_bf16 a[152:155], v[156:159], v[100:103], a[152:155]
    ds_read_b64_tr_b16 v[114:115], v11 offset:2048
    v_mfma_f32_16x16x32_bf16 a[156:159], v[156:159], v[104:107], a[156:159]
    buffer_load_dwordx4 v29, s[8:11], s19 offen lds
    v_mfma_f32_16x16x32_bf16 a[160:163], v[160:163], v[76:79], a[160:163]
    s_add_u32 m0, s21, 0x1c000
    v_mfma_f32_16x16x32_bf16 a[164:167], v[160:163], v[80:83], a[164:167]
    ds_read_b64_tr_b16 v[116:117], v12 offset:0
    v_mfma_f32_16x16x32_bf16 a[168:171], v[160:163], v[84:87], a[168:171]
    buffer_load_dwordx4 v30, s[8:11], s19 offen lds
    v_mfma_f32_16x16x32_bf16 a[172:175], v[160:163], v[88:91], a[172:175]
    s_add_u32 m0, s21, 0x1d000
    v_mfma_f32_16x16x32_bf16 a[176:179], v[160:163], v[92:95], a[176:179]
    ds_read_b64_tr_b16 v[118:119], v12 offset:2048
    v_mfma_f32_16x16x32_bf16 a[180:183], v[160:163], v[96:99], a[180:183]
    buffer_load_dwordx4 v31, s[8:11], s19 offen lds
    v_mfma_f32_16x16x32_bf16 a[184:187], v[160:163], v[100:103], a[184:187]
    s_add_u32 m0, s21, 0x1e000
    v_mfma_f32_16x16x32_bf16 a[188:191], v[160:163], v[104:107], a[188:191]
    ds_read_b64_tr_b16 v[120:121], v13 offset:0
    v_mfma_f32_16x16x32_bf16 a[192:195], v[164:167], v[76:79], a[192:195]
    buffer_load_dwordx4 v32, s[8:11], s19 offen lds
    v_mfma_f32_16x16x32_bf16 a[196:199], v[164:167], v[80:83], a[196:199]
    s_add_u32 m0, s21, 0x1f000
    v_mfma_f32_16x16x32_bf16 a[200:203], v[164:167], v[84:87], a[200:203]
    ds_read_b64_tr_b16 v[122:123], v13 offset:2048
    v_mfma_f32_16x16x32_bf16 a[204:207], v[164:167], v[88:91], a[204:207]
    buffer_load_dwordx4 v33, s[8:11], s19 offen lds
    v_mfma_f32_16x16x32_bf16 a[208:211], v[164:167], v[92:95], a[208:211]
    s_add_u32 s18, s18, 128
    v_mfma_f32_16x16x32_bf16 a[212:215], v[164:167], v[96:99], a[212:215]
    s_add_u32 s19, s19, s22
    v_mfma_f32_16x16x32_bf16 a[216:219], v[164:167], v[100:103], a[216:219]
    ds_read_b64_tr_b16 v[124:125], v14 offset:0
    v_mfma_f32_16x16x32_bf16 a[220:223], v[164:167], v[104:107], a[220:223]
    ds_read_b64_tr_b16 v[126:127], v14 offset:2048
    v_mfma_f32_16x16x32_bf16 a[224:227], v[168:171], v[76:79], a[224:227]
    ds_read_b64_tr_b16 v[128:129], v15 offset:0
    v_mfma_f32_16x16x32_bf16 a[228:231], v[168:171], v[80:83], a[228:231]
    ds_read_b64_tr_b16 v[130:131], v15 offset:2048
    v_mfma_f32_16x16x32_bf16 a[232:235], v[168:171], v[84:87], a[232:235]
    ds_read_b64_tr_b16 v[132:133], v16 offset:0
    v_mfma_f32_16x16x32_bf16 a[236:239], v[168:171], v[88:91], a[236:239]
    ds_read_b64_tr_b16 v[134:135], v16 offset:2048
    v_mfma_f32_16x16x32_bf16 a[240:243], v[168:171], v[92:95], a[240:243]
    ds_read_b64_tr_b16 v[136:137], v17 offset:0
    v_mfma_f32_16x16x32_bf16 a[244:247], v[168:171], v[96:99], a[244:247]
    ds_read_b64_tr_b16 v[138:139], v17 offset:2048
    v_mfma_f32_16x16x32_bf16 a[248:251], v[168:171], v[100:103], a[248:251]
    v_mfma_f32_16x16x32_bf16 a[252:255], v[168:171], v[104:107], a[252:255]
    s_sub_u32 s20, s20, 1
    s_cmp_eq_u32 s20, 0
    s_cbranch_scc1 L_g1_loop_skip
L_g1_loop:
    s_waitcnt lgkmcnt(15)
    v_mfma_f32_16x16x32_bf16 a[0:3], v[108:111], v[44:47], a[0:3]
    ds_read_b64_tr_b16 v[140:141], v10 offset:16384
    v_mfma_f32_16x16x32_bf16 a[4:7], v[108:111], v[48:51], a[4:7]
    ds_read_b64_tr_b16 v[142:143], v10 offset:18432
    v_mfma_f32_16x16x32_bf16 a[8:11], v[108:111], v[52:55], a[8:11]
    ds_read_b128 v[76:79], v9 offset:0
    v_mfma_f32_16x16x32_bf16 a[12:15], v[108:111], v[56:59], a[12:15]
    ds_read_b128 v[80:83], v9 offset:2048
    v_mfma_f32_16x16x32_bf16 a[16:19], v[108:111], v[60:63], a[16:19]
    ds_read_b128 v[84:87], v9 offset:4096
    v_mfma_f32_16x16x32_bf16 a[20:23], v[108:111], v[64:67], a[20:23]
    ds_read_b128 v[88:91], v9 offset:6144
    v_mfma_f32_16x16x32_bf16 a[24:27], v[108:111], v[68:71], a[24:27]
    ds_read_b128 v[92:95], v9 offset:8192
    s_waitcnt lgkmcnt(15)
    v_mfma_f32_16x16x32_bf16 a[28:31], v[108:111], v[72:75], a[28:31]
    ds_read_b128 v[96:99], v9 offset:10240
    v_mfma_f32_16x16x32_bf16 a[32:35], v[112:115], v[44:47], a[32:35]
    ds_read_b128 v[100:103], v9 offset:12288
    v_mfma_f32_16x16x32_bf16 a[36:39], v[112:115], v[48:51], a[36:39]
    ds_read_b128 v[104:107], v9 offset:14336
    v_mfma_f32_16x16x32_bf16 a[40:43], v[112:115], v[52:55], a[40:43]
    ds_read_b64_tr_b16 v[144:145], v11 offset:16384
    v_mfma_f32_16x16x32_bf16 a[44:47], v[112:115], v[56:59], a[44:47]
    ds_read_b64_tr_b16 v[146:147], v11 offset:18432
    v_mfma_f32_16x16x32_bf16 a[48:51], v[112:115], v[60:63], a[48:51]
    ds_read_b64_tr_b16 v[148:149], v12 offset:16384
    v_mfma_f32_16x16x32_bf16 a[52:55], v[112:115], v[64:67], a[52:55]
    ds_read_b64_tr_b16 v[150:151], v12 offset:18432
    v_mfma_f32_16x16x32_bf16 a[56:59], v[112:115], v[68:71], a[56:59]
    ds_read_b64_tr_b16 v[152:153], v13 offset:16384
    v_mfma_f32_16x16x32_bf16 a[60:63], v[112:115], v[72:75], a[60:63]
    ds_read_b64_tr_b16 v[154:155], v13 offset:18432
    v_mfma_f32_16x16x32_bf16 a[64:67], v[116:119], v[44:47], a[64:67]
    ds_read_b64_tr_b16 v[156:157], v14 offset:16384
    v_mfma_f32_16x16x32_bf16 a[68:71], v[116:119], v[48:51], a[68:71]
    ds_read_b64_tr_b16 v[158:159], v14 offset:18432
    v_mfma_f32_16x16x32_bf16 a[72:75], v[116:119], v[52:55], a[72:75]
    ds_read_b64_tr_b16 v[160:161], v15 offset:16384
    v_mfma_f32_16x16x32_bf16 a[76:79], v[116:119], v[56:59], a[76:79]
    ds_read_b64_tr_b16 v[162:163], v15 offset:18432
    v_mfma_f32_16x16x32_bf16 a[80:83], v[116:119], v[60:63], a[80:83]
    ds_read_b64_tr_b16 v[164:165], v16 offset:16384
    v_mfma_f32_16x16x32_bf16 a[84:87], v[116:119], v[64:67], a[84:87]
    ds_read_b64_tr_b16 v[166:167], v16 offset:18432
    v_mfma_f32_16x16x32_bf16 a[88:91], v[116:119], v[68:71], a[88:91]
    ds_read_b64_tr_b16 v[168:169], v17 offset:16384
    v_mfma_f32_16x16x32_bf16 a[92:95], v[116:119], v[72:75], a[92:95]
    ds_read_b64_tr_b16 v[170:171], v17 offset:18432
    v_mfma_f32_16x16x32_bf16 a[96:99], v[120:123], v[44:47], a[96:99]
    v_mfma_f32_16x16x32_bf16 a[100:103], v[120:123], v[48:51], a[100:103]
    v_mfma_f32_16x16x32_bf16 a[104:107], v[120:123], v[52:55], a[104:107]
    v_mfma_f32_16x16x32_bf16 a[108:111], v[120:123], v[56:59], a[108:111]
    v_mfma_f32_16x16x32_bf16 a[112:115], v[120:123], v[60:63], a[112:115]
    v_mfma_f32_16x16x32_bf16 a[116:119], v[120:123], v[64:67], a[116:119]
    v_mfma_f32_16x16x32_bf16 a[120:123], v[120:123], v[68:71], a[120:123]
    v_mfma_f32_16x16x32_bf16 a[124:127], v[120:123], v[72:75], a[124:127]
    s_waitcnt lgkmcnt(15)
    v_mfma_f32_16x16x32_bf16 a[128:131], v[124:127], v[44:47], a[128:131]
    v_mfma_f32_16x16x32_bf16 a[132:135], v[124:127], v[48:51], a[132:135]
    v_mfma_f32_16x16x32_bf16 a[136:139], v[124:127], v[52:55], a[136:139]
    v_mfma_f32_16x16x32_bf16 a[140:143], v[124:127], v[56:59], a[140:143]
    v_mfma_f32_16x16x32_bf16 a[144:147], v[124:127], v[60:63], a[144:147]
    v_mfma_f32_16x16x32_bf16 a[148:151], v[124:127], v[64:67], a[148:151]
    v_mfma_f32_16x16x32_bf16 a[152:155], v[124:127], v[68:71], a[152:155]
    v_mfma_f32_16x16x32_bf16 a[156:159], v[124:127], v[72:75], a[156:159]
    v_mfma_f32_16x16x32_bf16 a[160:163], v[128:131], v[44:47], a[160:163]
    v_mfma_f32_16x16x32_bf16 a[164:167], v[128:131], v[48:51], a[164:167]
    v_mfma_f32_16x16x32_bf16 a[168:171], v[128:131], v[52:55], a[168:171]
    v_mfma_f32_16x16x32_bf16 a[172:175], v[128:131], v[56:59], a[172:175]
    v_mfma_f32_16x16x32_bf16 a[176:179], v[128:131], v[60:63], a[176:179]
    v_mfma_f32_16x16x32_bf16 a[180:183], v[128:131], v[64:67], a[180:183]
    v_mfma_f32_16x16x32_bf16 a[184:187], v[128:131], v[68:71], a[184:187]
    v_mfma_f32_16x16x32_bf16 a[188:191], v[128:131], v[72:75], a[188:191]
    v_mfma_f32_16x16x32_bf16 a[192:195], v[132:135], v[44:47], a[192:195]
    v_mfma_f32_16x16x32_bf16 a[196:199], v[132:135], v[48:51], a[196:199]
    v_mfma_f32_16x16x32_bf16 a[200:203], v[132:135], v[52:55], a[200:203]
    v_mfma_f32_16x16x32_bf16 a[204:207], v[132:135], v[56:59], a[204:207]
    v_mfma_f32_16x16x32_bf16 a[208:211], v[132:135], v[60:63], a[208:211]
    v_mfma_f32_16x16x32_bf16 a[212:215], v[132:135], v[64:67], a[212:215]
    v_mfma_f32_16x16x32_bf16 a[216:219], v[132:135], v[68:71], a[216:219]
    v_mfma_f32_16x16x32_bf16 a[220:223], v[132:135], v[72:75], a[220:223]
    v_mfma_f32_16x16x32_bf16 a[224:227], v[136:139], v[44:47], a[224:227]
    v_mfma_f32_16x16x32_bf16 a[228:231], v[136:139], v[48:51], a[228:231]
    v_mfma_f32_16x16x32_bf16 a[232:235], v[136:139], v[52:55], a[232:235]
    v_mfma_f32_16x16x32_bf16 a[236:239], v[136:139], v[56:59], a[236:239]
    v_mfma_f32_16x16x32_bf16 a[240:243], v[136:139], v[60:63], a[240:243]
    v_mfma_f32_16x16x32_bf16 a[244:247], v[136:139], v[64:67], a[244:247]
    v_mfma_f32_16x16x32_bf16 a[248:251], v[136:139], v[68:71], a[248:251]
    v_mfma_f32_16x16x32_bf16 a[252:255], v[136:139], v[72:75], a[252:255]
    v_mfma_f32_16x16x32_bf16 a[0:3], v[140:143], v[76:79], a[0:3]
    v_mfma_f32_16x16x32_bf16 a[4:7], v[140:143], v[80:83], a[4:7]
    v_mfma_f32_16x16x32_bf16 a[8:11], v[140:143], v[84:87], a[8:11]
    v_mfma_f32_16x16x32_bf16 a[12:15], v[140:143], v[88:91], a[12:15]
    s_waitcnt lgkmcnt(0)
    s_waitcnt vmcnt(0)
    s_barrier
    v_mfma_f32_16x16x32_bf16 a[16:19], v[140:143], v[92:95], a[16:19]
    s_add_u32 m0, s21, 0x0
    v_mfma_f32_16x16x32_bf16 a[20:23], v[140:143], v[96:99], a[20:23]
    ds_read_b64_tr_b16 v[108:109], v10 offset:32768
    v_mfma_f32_16x16x32_bf16 a[24:27], v[140:143], v[100:103], a[24:27]
    buffer_load_dwordx4 v18, s[4:7], s18 offen lds
    v_mfma_f32_16x16x32_bf16 a[28:31], v[140:143], v[104:107], a[28:31]
    s_add_u32 m0, s21, 0x1000
    v_mfma_f32_16x16x32_bf16 a[32:35], v[144:147], v[76:79], a[32:35]
    ds_read_b64_tr_b16 v[110:111], v10 offset:34816
    v_mfma_f32_16x16x32_bf16 a[36:39], v[144:147], v[80:83], a[36:39]
    buffer_load_dwordx4 v19, s[4:7], s18 offen lds
    v_mfma_f32_16x16x32_bf16 a[40:43], v[144:147], v[84:87], a[40:43]
    s_add_u32 m0, s21, 0x2000
    v_mfma_f32_16x16x32_bf16 a[44:47], v[144:147], v[88:91], a[44:47]
    ds_read_b128 v[44:47], v8 offset:32768
    v_mfma_f32_16x16x32_bf16 a[48:51], v[144:147], v[92:95], a[48:51]
    buffer_load_dwordx4 v20, s[4:7], s18 offen lds
    v_mfma_f32_16x16x32_bf16 a[52:55], v[144:147], v[96:99], a[52:55]
    s_add_u32 m0, s21, 0x3000
    v_mfma_f32_16x16x32_bf16 a[56:59], v[144:147], v[100:103], a[56:59]
    ds_read_b128 v[48:51], v8 offset:34816
    v_mfma_f32_16x16x32_bf16 a[60:63], v[144:147], v[104:107], a[60:63]
    buffer_load_dwordx4 v21, s[4:7], s18 offen lds
    v_mfma_f32_16x16x32_bf16 a[64:67], v[148:151], v[76:79], a[64:67]
    s_add_u32 m0, s21, 0x4000
    v_mfma_f32_16x16x32_bf16 a[68:71], v[148:151], v[80:83], a[68:71]
    ds_read_b128 v[52:55], v8 offset:36864
    v_mfma_f32_16x16x32_bf16 a[72:75], v[148:151], v[84:87], a[72:75]
    buffer_load_dwordx4 v22, s[4:7], s18 offen lds
    v_mfma_f32_16x16x32_bf16 a[76:79], v[148:151], v[88:91], a[76:79]
    s_add_u32 m0, s21, 0x5000
    v_mfma_f32_16x16x32_bf16 a[80:83], v[148:151], v[92:95], a[80:83]
    ds_read_b128 v[56:59], v8 offset:38912
    v_mfma_f32_16x16x32_bf16 a[84:87], v[148:151], v[96:99], a[84:87]
    buffer_load_dwordx4 v23, s[4:7], s18 offen lds
    v_mfma_f32_16x16x32_bf16 a[88:91], v[148:151], v[100:103], a[88:91]
    s_add_u32 m0, s21, 0x6000
    v_mfma_f32_16x16x32_bf16 a[92:95], v[148:151], v[104:107], a[92:95]
    ds_read_b128 v[60:63], v8 offset:40960
    v_mfma_f32_16x16x32_bf16 a[96:99], v[152:155], v[76:79], a[96:99]
    buffer_load_dwordx4 v24, s[4:7], s18 offen lds
    v_mfma_f32_16x16x32_bf16 a[100:103], v[152:155], v[80:83], a[100:103]
    s_add_u32 m0, s21, 0x7000
    v_mfma_f32_16x16x32_bf16 a[104:107], v[152:155], v[84:87], a[104:107]
    ds_read_b128 v[64:67], v8 offset:43008
    v_mfma_f32_16x16x32_bf16 a[108:111], v[152:155], v[88:91], a[108:111]
    buffer_load_dwordx4 v25, s[4:7], s18 offen lds
    v_mfma_f32_16x16x32_bf16 a[112:115], v[152:155], v[92:95], a[112:115]
    s_add_u32 m0, s21, 0x10000
    v_mfma_f32_16x16x32_bf16 a[116:119], v[152:155], v[96:99], a[116:119]
    ds_read_b128 v[68:71], v8 offset:45056
    v_mfma_f32_16x16x32_bf16 a[120:123], v[152:155], v[100:103], a[120:123]
    buffer_load_dwordx4 v26, s[8:11], s19 offen lds
    v_mfma_f32_16x16x32_bf16 a[124:127], v[152:155], v[104:107], a[124:127]
    s_add_u32 m0, s21, 0x11000
    v_mfma_f32_16x16x32_bf16 a[128:131], v[156:159], v[76:79], a[128:131]
    ds_read_b128 v[72:75], v8 offset:47104
    v_mfma_f32_16x16x32_bf16 a[132:135], v[156:159], v[80:83], a[132:135]
    buffer_load_dwordx4 v27, s[8:11], s19 offen lds
    v_mfma_f32_16x16x32_bf16 a[136:139], v[156:159], v[84:87], a[136:139]
    s_add_u32 m0, s21, 0x12000
    v_mfma_f32_16x16x32_bf16 a[140:143], v[156:159], v[88:91], a[140:143]
    ds_read_b64_tr_b16 v[112:113], v11 offset:32768
    v_mfma_f32_16x16x32_bf16 a[144:147], v[156:159], v[92:95], a[144:147]
    buffer_load_dwordx4 v28, s[8:11], s19 offen lds
    v_mfma_f32_16x16x32_bf16 a[148:151], v[156:159], v[96:99], a[148:151]
    s_add_u32 m0, s21, 0x13000
    v_mfma_f32_16x16x32_bf16 a[152:155], v[156:159], v[100:103], a[152:155]
    ds_read_b64_tr_b16 v[114:115], v11 offset:34816
    v_mfma_f32_16x16x32_bf16 a[156:159], v[156:159], v[104:107], a[156:159]
    buffer_load_dwordx4 v29, s[8:11], s19 offen lds
    v_mfma_f32_16x16x32_bf16 a[160:163], v[160:163], v[76:79], a[160:163]
    s_add_u32 m0, s21, 0x14000
    v_mfma_f32_16x16x32_bf16 a[164:167], v[160:163], v[80:83], a[164:167]
    ds_read_b64_tr_b16 v[116:117], v12 offset:32768
    v_mfma_f32_16x16x32_bf16 a[168:171], v[160:163], v[84:87], a[168:171]
    buffer_load_dwordx4 v30, s[8:11], s19 offen lds
    v_mfma_f32_16x16x32_bf16 a[172:175], v[160:163], v[88:91], a[172:175]
    s_add_u32 m0, s21, 0x15000
    v_mfma_f32_16x16x32_bf16 a[176:179], v[160:163], v[92:95], a[176:179]
    ds_read_b64_tr_b16 v[118:119], v12 offset:34816
    v_mfma_f32_16x16x32_bf16 a[180:183], v[160:163], v[96:99], a[180:183]
    buffer_load_dwordx4 v31, s[8:11], s19 offen lds
    v_mfma_f32_16x16x32_bf16 a[184:187], v[160:163], v[100:103], a[184:187]
    s_add_u32 m0, s21, 0x16000
    v_mfma_f32_16x16x32_bf16 a[188:191], v[160:163], v[104:107], a[188:191]
    ds_read_b64_tr_b16 v[120:121], v13 offset:32768
    v_mfma_f32_16x16x32_bf16 a[192:195], v[164:167], v[76:79], a[192:195]
    buffer_load_dwordx4 v32, s[8:11], s19 offen lds
    v_mfma_f32_16x16x32_bf16 a[196:199], v[164:167], v[80:83], a[196:199]
    s_add_u32 m0, s21, 0x17000
    v_mfma_f32_16x16x32_bf16 a[200:203], v[164:167], v[84:87], a[200:203]
    ds_read_b64_tr_b16 v[122:123], v13 offset:34816
    v_mfma_f32_16x16x32_bf16 a[204:207], v[164:167], v[88:91], a[204:207]
    buffer_load_dwordx4 v33, s[8:11], s19 offen lds
    v_mfma_f32_16x16x32_bf16 a[208:211], v[164:167], v[92:95], a[208:211]
    s_add_u32 s18, s18, 128
    v_mfma_f32_16x16x32_bf16 a[212:215], v[164:167], v[96:99], a[212:215]
    s_add_u32 s19, s19, s22
    v_mfma_f32_16x16x32_bf16 a[216:219], v[164:167], v[100:103], a[216:219]
    ds_read_b64_tr_b16 v[124:125], v14 offset:32768
    v_mfma_f32_16x16x32_bf16 a[220:223], v[164:167], v[104:107], a[220:223]
    ds_read_b64_tr_b16 v[126:127], v14 offset:34816
    v_mfma_f32_16x16x32_bf16 a[224:227], v[168:171], v[76:79], a[224:227]
    ds_read_b64_tr_b16 v[128:129], v15 offset:32768
    v_mfma_f32_16x16x32_bf16 a[228:231], v[168:171], v[80:83], a[228:231]
    ds_read_b64_tr_b16 v[130:131], v15 offset:34816
    v_mfma_f32_16x16x32_bf16 a[232:235], v[168:171], v[84:87], a[232:235]
    ds_read_b64_tr_b16 v[132:133], v16 offset:32768
    v_mfma_f32_16x16x32_bf16 a[236:239], v[168:171], v[88:91], a[236:239]
    ds_read_b64_tr_b16 v[134:135], v16 offset:34816
    v_mfma_f32_16x16x32_bf16 a[240:243], v[168:171], v[92:95], a[240:243]
    ds_read_b64_tr_b16 v[136:137], v17 offset:32768
    v_mfma_f32_16x16x32_bf16 a[244:247], v[168:171], v[96:99], a[244:247]
    ds_read_b64_tr_b16 v[138:139], v17 offset:34816
    v_mfma_f32_16x16x32_bf16 a[248:251], v[168:171], v[100:103], a[248:251]
    v_mfma_f32_16x16x32_bf16 a[252:255], v[168:171], v[104:107], a[252:255]
    s_waitcnt lgkmcnt(15)
    v_mfma_f32_16x16x32_bf16 a[0:3], v[108:111], v[44:47], a[0:3]
    ds_read_b64_tr_b16 v[140:141], v10 offset:49152
    v_mfma_f32_16x16x32_bf16 a[4:7], v[108:111], v[48:51], a[4:7]
    ds_read_b64_tr_b16 v[142:143], v10 offset:51200
    v_mfma_f32_16x16x32_bf16 a[8:11], v[108:111], v[52:55], a[8:11]
    ds_read_b128 v[76:79], v9 offset:32768
    v_mfma_f32_16x16x32_bf16 a[12:15], v[108:111], v[56:59], a[12:15]
    ds_read_b128 v[80:83], v9 offset:34816
    v_mfma_f32_16x16x32_bf16 a[16:19], v[108:111], v[60:63], a[16:19]
    ds_read_b128 v[84:87], v9 offset:36864
    v_mfma_f32_16x16x32_bf16 a[20:23], v[108:111], v[64:67], a[20:23]
    ds_read_b128 v[88:91], v9 offset:38912
    v_mfma_f32_16x16x32_bf16 a[24:27], v[108:111], v[68:71], a[24:27]
    ds_read_b128 v[92:95], v9 offset:40960
    s_waitcnt lgkmcnt(15)
    v_mfma_f32_16x16x32_bf16 a[28:31], v[108:111], v[72:75], a[28:31]
    ds_read_b128 v[96:99], v9 offset:43008
    v_mfma_f32_16x16x32_bf16 a[32:35], v[112:115], v[44:47], a[32:35]
    ds_read_b128 v[100:103], v9 offset:45056
    v_mfma_f32_16x16x32_bf16 a[36:39], v[112:115], v[48:51], a[36:39]
    ds_read_b128 v[104:107], v9 offset:47104
    v_mfma_f32_16x16x32_bf16 a[40:43], v[112:115], v[52:55], a[40:43]
    ds_read_b64_tr_b16 v[144:145], v11 offset:49152
    v_mfma_f32_16x16x32_bf16 a[44:47], v[112:115], v[56:59], a[44:47]
    ds_read_b64_tr_b16 v[146:147], v11 offset:51200
    v_mfma_f32_16x16x32_bf16 a[48:51], v[112:115], v[60:63], a[48:51]
    ds_read_b64_tr_b16 v[148:149], v12 offset:49152
    v_mfma_f32_16x16x32_bf16 a[52:55], v[112:115], v[64:67], a[52:55]
    ds_read_b64_tr_b16 v[150:151], v12 offset:51200
    v_mfma_f32_16x16x32_bf16 a[56:59], v[112:115], v[68:71], a[56:59]
    ds_read_b64_tr_b16 v[152:153], v13 offset:49152
    v_mfma_f32_16x16x32_bf16 a[60:63], v[112:115], v[72:75], a[60:63]
    ds_read_b64_tr_b16 v[154:155], v13 offset:51200
    v_mfma_f32_16x16x32_bf16 a[64:67], v[116:119], v[44:47], a[64:67]
    ds_read_b64_tr_b16 v[156:157], v14 offset:49152
    v_mfma_f32_16x16x32_bf16 a[68:71], v[116:119], v[48:51], a[68:71]
    ds_read_b64_tr_b16 v[158:159], v14 offset:51200
    v_mfma_f32_16x16x32_bf16 a[72:75], v[116:119], v[52:55], a[72:75]
    ds_read_b64_tr_b16 v[160:161], v15 offset:49152
    v_mfma_f32_16x16x32_bf16 a[76:79], v[116:119], v[56:59], a[76:79]
    ds_read_b64_tr_b16 v[162:163], v15 offset:51200
    v_mfma_f32_16x16x32_bf16 a[80:83], v[116:119], v[60:63], a[80:83]
    ds_read_b64_tr_b16 v[164:165], v16 offset:49152
    v_mfma_f32_16x16x32_bf16 a[84:87], v[116:119], v[64:67], a[84:87]
    ds_read_b64_tr_b16 v[166:167], v16 offset:51200
    v_mfma_f32_16x16x32_bf16 a[88:91], v[116:119], v[68:71], a[88:91]
    ds_read_b64_tr_b16 v[168:169], v17 offset:49152
    v_mfma_f32_16x16x32_bf16 a[92:95], v[116:119], v[72:75], a[92:95]
    ds_read_b64_tr_b16 v[170:171], v17 offset:51200
    v_mfma_f32_16x16x32_bf16 a[96:99], v[120:123], v[44:47], a[96:99]
    v_mfma_f32_16x16x32_bf16 a[100:103], v[120:123], v[48:51], a[100:103]
    v_mfma_f32_16x16x32_bf16 a[104:107], v[120:123], v[52:55], a[104:107]
    v_mfma_f32_16x16x32_bf16 a[108:111], v[120:123], v[56:59], a[108:111]
    v_mfma_f32_16x16x32_bf16 a[112:115], v[120:123], v[60:63], a[112:115]
    v_mfma_f32_16x16x32_bf16 a[116:119], v[120:123], v[64:67], a[116:119]
    v_mfma_f32_16x16x32_bf16 a[120:123], v[120:123], v[68:71], a[120:123]
    v_mfma_f32_16x16x32_bf16 a[124:127], v[120:123], v[72:75], a[124:127]
    s_waitcnt lgkmcnt(15)
    v_mfma_f32_16x16x32_bf16 a[128:131], v[124:127], v[44:47], a[128:131]
    v_mfma_f32_16x16x32_bf16 a[132:135], v[124:127], v[48:51], a[132:135]
    v_mfma_f32_16x16x32_bf16 a[136:139], v[124:127], v[52:55], a[136:139]
    v_mfma_f32_16x16x32_bf16 a[140:143], v[124:127], v[56:59], a[140:143]
    v_mfma_f32_16x16x32_bf16 a[144:147], v[124:127], v[60:63], a[144:147]
    v_mfma_f32_16x16x32_bf16 a[148:151], v[124:127], v[64:67], a[148:151]
    v_mfma_f32_16x16x32_bf16 a[152:155], v[124:127], v[68:71], a[152:155]
    v_mfma_f32_16x16x32_bf16 a[156:159], v[124:127], v[72:75], a[156:159]
    v_mfma_f32_16x16x32_bf16 a[160:163], v[128:131], v[44:47], a[160:163]
    v_mfma_f32_16x16x32_bf16 a[164:167], v[128:131], v[48:51], a[164:167]
    v_mfma_f32_16x16x32_bf16 a[168:171], v[128:131], v[52:55], a[168:171]
    v_mfma_f32_16x16x32_bf16 a[172:175], v[128:131], v[56:59], a[172:175]
    v_mfma_f32_16x16x32_bf16 a[176:179], v[128:131], v[60:63], a[176:179]
    v_mfma_f32_16x16x32_bf16 a[180:183], v[128:131], v[64:67], a[180:183]
    v_mfma_f32_16x16x32_bf16 a[184:187], v[128:131], v[68:71], a[184:187]
    v_mfma_f32_16x16x32_bf16 a[188:191], v[128:131], v[72:75], a[188:191]
    v_mfma_f32_16x16x32_bf16 a[192:195], v[132:135], v[44:47], a[192:195]
    v_mfma_f32_16x16x32_bf16 a[196:199], v[132:135], v[48:51], a[196:199]
    v_mfma_f32_16x16x32_bf16 a[200:203], v[132:135], v[52:55], a[200:203]
    v_mfma_f32_16x16x32_bf16 a[204:207], v[132:135], v[56:59], a[204:207]
    v_mfma_f32_16x16x32_bf16 a[208:211], v[132:135], v[60:63], a[208:211]
    v_mfma_f32_16x16x32_bf16 a[212:215], v[132:135], v[64:67], a[212:215]
    v_mfma_f32_16x16x32_bf16 a[216:219], v[132:135], v[68:71], a[216:219]
    v_mfma_f32_16x16x32_bf16 a[220:223], v[132:135], v[72:75], a[220:223]
    v_mfma_f32_16x16x32_bf16 a[224:227], v[136:139], v[44:47], a[224:227]
    v_mfma_f32_16x16x32_bf16 a[228:231], v[136:139], v[48:51], a[228:231]
    v_mfma_f32_16x16x32_bf16 a[232:235], v[136:139], v[52:55], a[232:235]
    v_mfma_f32_16x16x32_bf16 a[236:239], v[136:139], v[56:59], a[236:239]
    v_mfma_f32_16x16x32_bf16 a[240:243], v[136:139], v[60:63], a[240:243]
    v_mfma_f32_16x16x32_bf16 a[244:247], v[136:139], v[64:67], a[244:247]
    v_mfma_f32_16x16x32_bf16 a[248:251], v[136:139], v[68:71], a[248:251]
    v_mfma_f32_16x16x32_bf16 a[252:255], v[136:139], v[72:75], a[252:255]
    v_mfma_f32_16x16x32_bf16 a[0:3], v[140:143], v[76:79], a[0:3]
    v_mfma_f32_16x16x32_bf16 a[4:7], v[140:143], v[80:83], a[4:7]
    v_mfma_f32_16x16x32_bf16 a[8:11], v[140:143], v[84:87], a[8:11]
    v_mfma_f32_16x16x32_bf16 a[12:15], v[140:143], v[88:91], a[12:15]
    s_waitcnt lgkmcnt(0)
    s_waitcnt vmcnt(0)
    s_barrier
    v_mfma_f32_16x16x32_bf16 a[16:19], v[140:143], v[92:95], a[16:19]
    s_add_u32 m0, s21, 0x8000
    v_mfma_f32_16x16x32_bf16 a[20:23], v[140:143], v[96:99], a[20:23]
    ds_read_b64_tr_b16 v[108:109], v10 offset:0
    v_mfma_f32_16x16x32_bf16 a[24:27], v[140:143], v[100:103], a[24:27]
    buffer_load_dwordx4 v18, s[4:7], s18 offen lds
    v_mfma_f32_16x16x32_bf16 a[28:31], v[140:143], v[104:107], a[28:31]
    s_add_u32 m0, s21, 0x9000
    v_mfma_f32_16x16x32_bf16 a[32:35], v[144:147], v[76:79], a[32:35]
    ds_read_b64_tr_b16 v[110:111], v10 offset:2048
    v_mfma_f32_16x16x32_bf16 a[36:39], v[144:147], v[80:83], a[36:39]
    buffer_load_dwordx4 v19, s[4:7], s18 offen lds
    v_mfma_f32_16x16x32_bf16 a[40:43], v[144:147], v[84:87], a[40:43]
    s_add_u32 m0, s21, 0xa000
    v_mfma_f32_16x16x32_bf16 a[44:47], v[144:147], v[88:91], a[44:47]
    ds_read_b128 v[44:47], v8 offset:0
    v_mfma_f32_16x16x32_bf16 a[48:51], v[144:147], v[92:95], a[48:51]
    buffer_load_dwordx4 v20, s[4:7], s18 offen lds
    v_mfma_f32_16x16x32_bf16 a[52:55], v[144:147], v[96:99], a[52:55]
    s_add_u32 m0, s21, 0xb000
    v_mfma_f32_16x16x32_bf16 a[56:59], v[144:147], v[100:103], a[56:59]
    ds_read_b128 v[48:51], v8 offset:2048
    v_mfma_f32_16x16x32_bf16 a[60:63], v[144:147], v[104:107], a[60:63]
    buffer_load_dwordx4 v21, s[4:7], s18 offen lds
    v_mfma_f32_16x16x32_bf16 a[64:67], v[148:151], v[76:79], a[64:67]
    s_add_u32 m0, s21, 0xc000
    v_mfma_f32_16x16x32_bf16 a[68:71], v[148:151], v[80:83], a[68:71]
    ds_read_b128 v[52:55], v8 offset:4096
    v_mfma_f32_16x16x32_bf16 a[72:75], v[148:151], v[84:87], a[72:75]
    buffer_load_dwordx4 v22, s[4:7], s18 offen lds
    v_mfma_f32_16x16x32_bf16 a[76:79], v[148:151], v[88:91], a[76:79]
    s_add_u32 m0, s21, 0xd000
    v_mfma_f32_16x16x32_bf16 a[80:83], v[148:151], v[92:95], a[80:83]
    ds_read_b128 v[56:59], v8 offset:6144
    v_mfma_f32_16x16x32_bf16 a[84:87], v[148:151], v[96:99], a[84:87]
    buffer_load_dwordx4 v23, s[4:7], s18 offen lds
    v_mfma_f32_16x16x32_bf16 a[88:91], v[148:151], v[100:103], a[88:91]
    s_add_u32 m0, s21, 0xe000
    v_mfma_f32_16x16x32_bf16 a[92:95], v[148:151], v[104:107], a[92:95]
    ds_read_b128 v[60:63], v8 offset:8192
    v_mfma_f32_16x16x32_bf16 a[96:99], v[152:155], v[76:79], a[96:99]
    buffer_load_dwordx4 v24, s[4:7], s18 offen lds
    v_mfma_f32_16x16x32_bf16 a[100:103], v[152:155], v[80:83], a[100:103]
    s_add_u32 m0, s21, 0xf000
    v_mfma_f32_16x16x32_bf16 a[104:107], v[152:155], v[84:87], a[104:107]
    ds_read_b128 v[64:67], v8 offset:10240
    v_mfma_f32_16x16x32_bf16 a[108:111], v[152:155], v[88:91], a[108:111]
    buffer_load_dwordx4 v25, s[4:7], s18 offen lds
    v_mfma_f32_16x16x32_bf16 a[112:115], v[152:155], v[92:95], a[112:115]
    s_add_u32 m0, s21, 0x18000
    v_mfma_f32_16x16x32_bf16 a[116:119], v[152:155], v[96:99], a[116:119]
    ds_read_b128 v[68:71], v8 offset:12288
    v_mfma_f32_16x16x32_bf16 a[120:123], v[152:155], v[100:103], a[120:123]
    buffer_load_dwordx4 v26, s[8:11], s19 offen lds
    v_mfma_f32_16x16x32_bf16 a[124:127], v[152:155], v[104:107], a[124:127]
    s_add_u32 m0, s21, 0x19000
    v_mfma_f32_16x16x32_bf16 a[128:131], v[156:159], v[76:79], a[128:131]
    ds_read_b128 v[72:75], v8 offset:14336
    v_mfma_f32_16x16x32_bf16 a[132:135], v[156:159], v[80:83], a[132:135]
    buffer_load_dwordx4 v27, s[8:11], s19 offen lds
    v_mfma_f32_16x16x32_bf16 a[136:139], v[156:159], v[84:87], a[136:139]
    s_add_u32 m0, s21, 0x1a000
    v_mfma_f32_16x16x32_bf16 a[140:143], v[156:159], v[88:91], a[140:143]
    ds_read_b64_tr_b16 v[112:113], v11 offset:0
    v_mfma_f32_16x16x32_bf16 a[144:147], v[156:159], v[92:95], a[144:147]
    buffer_load_dwordx4 v28, s[8:11], s19 offen lds
    v_mfma_f32_16x16x32_bf16 a[148:151], v[156:159], v[96:99], a[148:151]
    s_add_u32 m0, s21, 0x1b000
    v_mfma_f32_16x16x32_bf16 a[152:155], v[156:159], v[100:103], a[152:155]
    ds_read_b64_tr_b16 v[114:115], v11 offset:2048
    v_mfma_f32_16x16x32_bf16 a[156:159], v[156:159], v[104:107], a[156:159]
    buffer_load_dwordx4 v29, s[8:11], s19 offen lds
    v_mfma_f32_16x16x32_bf16 a[160:163], v[160:163], v[76:79], a[160:163]
    s_add_u32 m0, s21, 0x1c000
    v_mfma_f32_16x16x32_bf16 a[164:167], v[160:163], v[80:83], a[164:167]
    ds_read_b64_tr_b16 v[116:117], v12 offset:0
    v_mfma_f32_16x16x32_bf16 a[168:171], v[160:163], v[84:87], a[168:171]
    buffer_load_dwordx4 v30, s[8:11], s19 offen lds
    v_mfma_f32_16x16x32_bf16 a[172:175], v[160:163], v[88:91], a[172:175]
    s_add_u32 m0, s21, 0x1d000
    v_mfma_f32_16x16x32_bf16 a[176:179], v[160:163], v[92:95], a[176:179]
    ds_read_b64_tr_b16 v[118:119], v12 offset:2048
    v_mfma_f32_16x16x32_bf16 a[180:183], v[160:163], v[96:99], a[180:183]
    buffer_load_dwordx4 v31, s[8:11], s19 offen lds
    v_mfma_f32_16x16x32_bf16 a[184:187], v[160:163], v[100:103], a[184:187]
    s_add_u32 m0, s21, 0x1e000
    v_mfma_f32_16x16x32_bf16 a[188:191], v[160:163], v[104:107], a[188:191]
    ds_read_b64_tr_b16 v[120:121], v13 offset:0
    v_mfma_f32_16x16x32_bf16 a[192:195], v[164:167], v[76:79], a[192:195]
    buffer_load_dwordx4 v32, s[8:11], s19 offen lds
    v_mfma_f32_16x16x32_bf16 a[196:199], v[164:167], v[80:83], a[196:199]
    s_add_u32 m0, s21, 0x1f000
    v_mfma_f32_16x16x32_bf16 a[200:203], v[164:167], v[84:87], a[200:203]
    ds_read_b64_tr_b16 v[122:123], v13 offset:2048
    v_mfma_f32_16x16x32_bf16 a[204:207], v[164:167], v[88:91], a[204:207]
    buffer_load_dwordx4 v33, s[8:11], s19 offen lds
    v_mfma_f32_16x16x32_bf16 a[208:211], v[164:167], v[92:95], a[208:211]
    s_add_u32 s18, s18, 128
    v_mfma_f32_16x16x32_bf16 a[212:215], v[164:167], v[96:99], a[212:215]
    s_add_u32 s19, s19, s22
    v_mfma_f32_16x16x32_bf16 a[216:219], v[164:167], v[100:103], a[216:219]
    ds_read_b64_tr_b16 v[124:125], v14 offset:0
    v_mfma_f32_16x16x32_bf16 a[220:223], v[164:167], v[104:107], a[220:223]
    ds_read_b64_tr_b16 v[126:127], v14 offset:2048
    v_mfma_f32_16x16x32_bf16 a[224:227], v[168:171], v[76:79], a[224:227]
    ds_read_b64_tr_b16 v[128:129], v15 offset:0
    v_mfma_f32_16x16x32_bf16 a[228:231], v[168:171], v[80:83], a[228:231]
    ds_read_b64_tr_b16 v[130:131], v15 offset:2048
    v_mfma_f32_16x16x32_bf16 a[232:235], v[168:171], v[84:87], a[232:235]
    ds_read_b64_tr_b16 v[132:133], v16 offset:0
    v_mfma_f32_16x16x32_bf16 a[236:239], v[168:171], v[88:91], a[236:239]
    ds_read_b64_tr_b16 v[134:135], v16 offset:2048
    v_mfma_f32_16x16x32_bf16 a[240:243], v[168:171], v[92:95], a[240:243]
    ds_read_b64_tr_b16 v[136:137], v17 offset:0
    v_mfma_f32_16x16x32_bf16 a[244:247], v[168:171], v[96:99], a[244:247]
    ds_read_b64_tr_b16 v[138:139], v17 offset:2048
    v_mfma_f32_16x16x32_bf16 a[248:251], v[168:171], v[100:103], a[248:251]
    v_mfma_f32_16x16x32_bf16 a[252:255], v[168:171], v[104:107], a[252:255]
    s_sub_u32 s20, s20, 1
    s_cmp_lg_u32 s20, 0
    s_cbranch_scc1 L_g1_loop
L_g1_loop_skip:
    s_waitcnt lgkmcnt(15)
    v_mfma_f32_16x16x32_bf16 a[0:3], v[108:111], v[44:47], a[0:3]
    ds_read_b64_tr_b16 v[140:141], v10 offset:16384
    v_mfma_f32_16x16x32_bf16 a[4:7], v[108:111], v[48:51], a[4:7]
    ds_read_b64_tr_b16 v[142:143], v10 offset:18432
    v_mfma_f32_16x16x32_bf16 a[8:11], v[108:111], v[52:55], a[8:11]
    ds_read_b128 v[76:79], v9 offset:0
    v_mfma_f32_16x16x32_bf16 a[12:15], v[108:111], v[56:59], a[12:15]
    ds_read_b128 v[80:83], v9 offset:2048
    v_mfma_f32_16x16x32_bf16 a[16:19], v[108:111], v[60:63], a[16:19]
    ds_read_b128 v[84:87], v9 offset:4096
    v_mfma_f32_16x16x32_bf16 a[20:23], v[108:111], v[64:67], a[20:23]
    ds_read_b128 v[88:91], v9 offset:6144
    v_mfma_f32_16x16x32_bf16 a[24:27], v[108:111], v[68:71], a[24:27]
    ds_read_b128 v[92:95], v9 offset:8192
    s_waitcnt lgkmcnt(15)
    v_mfma_f32_16x16x32_bf16 a[28:31], v[108:111], v[72:75], a[28:31]
    ds_read_b128 v[96:99], v9 offset:10240
    v_mfma_f32_16x16x32_bf16 a[32:35], v[112:115], v[44:47], a[32:35]
    ds_read_b128 v[100:103], v9 offset:12288
    v_mfma_f32_16x16x32_bf16 a[36:39], v[112:115], v[48:51], a[36:39]
    ds_read_b128 v[104:107], v9 offset:14336
    v_mfma_f32_16x16x32_bf16 a[40:43], v[112:115], v[52:55], a[40:43]
    ds_read_b64_tr_b16 v[144:145], v11 offset:16384
    v_mfma_f32_16x16x32_bf16 a[44:47], v[112:115], v[56:59], a[44:47]
    ds_read_b64_tr_b16 v[146:147], v11 offset:18432
    v_mfma_f32_16x16x32_bf16 a[48:51], v[112:115], v[60:63], a[48:51]
    ds_read_b64_tr_b16 v[148:149], v12 offset:16384
    v_mfma_f32_16x16x32_bf16 a[52:55], v[112:115], v[64:67], a[52:55]
    ds_read_b64_tr_b16 v[150:151], v12 offset:18432
    v_mfma_f32_16x16x32_bf16 a[56:59], v[112:115], v[68:71], a[56:59]
    ds_read_b64_tr_b16 v[152:153], v13 offset:16384
    v_mfma_f32_16x16x32_bf16 a[60:63], v[112:115], v[72:75], a[60:63]
    ds_read_b64_tr_b16 v[154:155], v13 offset:18432
    v_mfma_f32_16x16x32_bf16 a[64:67], v[116:119], v[44:47], a[64:67]
    ds_read_b64_tr_b16 v[156:157], v14 offset:16384
    v_mfma_f32_16x16x32_bf16 a[68:71], v[116:119], v[48:51], a[68:71]
    ds_read_b64_tr_b16 v[158:159], v14 offset:18432
    v_mfma_f32_16x16x32_bf16 a[72:75], v[116:119], v[52:55], a[72:75]
    ds_read_b64_tr_b16 v[160:161], v15 offset:16384
    v_mfma_f32_16x16x32_bf16 a[76:79], v[116:119], v[56:59], a[76:79]
    ds_read_b64_tr_b16 v[162:163], v15 offset:18432
    v_mfma_f32_16x16x32_bf16 a[80:83], v[116:119], v[60:63], a[80:83]
    ds_read_b64_tr_b16 v[164:165], v16 offset:16384
    v_mfma_f32_16x16x32_bf16 a[84:87], v[116:119], v[64:67], a[84:87]
    ds_read_b64_tr_b16 v[166:167], v16 offset:18432
    v_mfma_f32_16x16x32_bf16 a[88:91], v[116:119], v[68:71], a[88:91]
    ds_read_b64_tr_b16 v[168:169], v17 offset:16384
    v_mfma_f32_16x16x32_bf16 a[92:95], v[116:119], v[72:75], a[92:95]
    ds_read_b64_tr_b16 v[170:171], v17 offset:18432
    v_mfma_f32_16x16x32_bf16 a[96:99], v[120:123], v[44:47], a[96:99]
    v_mfma_f32_16x16x32_bf16 a[100:103], v[120:123], v[48:51], a[100:103]
    v_mfma_f32_16x16x32_bf16 a[104:107], v[120:123], v[52:55], a[104:107]
    v_mfma_f32_16x16x32_bf16 a[108:111], v[120:123], v[56:59], a[108:111]
    v_mfma_f32_16x16x32_bf16 a[112:115], v[120:123], v[60:63], a[112:115]
    v_mfma_f32_16x16x32_bf16 a[116:119], v[120:123], v[64:67], a[116:119]
    v_mfma_f32_16x16x32_bf16 a[120:123], v[120:123], v[68:71], a[120:123]
    v_mfma_f32_16x16x32_bf16 a[124:127], v[120:123], v[72:75], a[124:127]
    s_waitcnt lgkmcnt(15)
    v_mfma_f32_16x16x32_bf16 a[128:131], v[124:127], v[44:47], a[128:131]
    v_mfma_f32_16x16x32_bf16 a[132:135], v[124:127], v[48:51], a[132:135]
    v_mfma_f32_16x16x32_bf16 a[136:139], v[124:127], v[52:55], a[136:139]
    v_mfma_f32_16x16x32_bf16 a[140:143], v[124:127], v[56:59], a[140:143]
    v_mfma_f32_16x16x32_bf16 a[144:147], v[124:127], v[60:63], a[144:147]
    v_mfma_f32_16x16x32_bf16 a[148:151], v[124:127], v[64:67], a[148:151]
    v_mfma_f32_16x16x32_bf16 a[152:155], v[124:127], v[68:71], a[152:155]
    v_mfma_f32_16x16x32_bf16 a[156:159], v[124:127], v[72:75], a[156:159]
    v_mfma_f32_16x16x32_bf16 a[160:163], v[128:131], v[44:47], a[160:163]
    v_mfma_f32_16x16x32_bf16 a[164:167], v[128:131], v[48:51], a[164:167]
    v_mfma_f32_16x16x32_bf16 a[168:171], v[128:131], v[52:55], a[168:171]
    v_mfma_f32_16x16x32_bf16 a[172:175], v[128:131], v[56:59], a[172:175]
    v_mfma_f32_16x16x32_bf16 a[176:179], v[128:131], v[60:63], a[176:179]
    v_mfma_f32_16x16x32_bf16 a[180:183], v[128:131], v[64:67], a[180:183]
    v_mfma_f32_16x16x32_bf16 a[184:187], v[128:131], v[68:71], a[184:187]
    v_mfma_f32_16x16x32_bf16 a[188:191], v[128:131], v[72:75], a[188:191]
    v_mfma_f32_16x16x32_bf16 a[192:195], v[132:135], v[44:47], a[192:195]
    v_mfma_f32_16x16x32_bf16 a[196:199], v[132:135], v[48:51], a[196:199]
    v_mfma_f32_16x16x32_bf16 a[200:203], v[132:135], v[52:55], a[200:203]
    v_mfma_f32_16x16x32_bf16 a[204:207], v[132:135], v[56:59], a[204:207]
    v_mfma_f32_16x16x32_bf16 a[208:211], v[132:135], v[60:63], a[208:211]
    v_mfma_f32_16x16x32_bf16 a[212:215], v[132:135], v[64:67], a[212:215]
    v_mfma_f32_16x16x32_bf16 a[216:219], v[132:135], v[68:71], a[216:219]
    v_mfma_f32_16x16x32_bf16 a[220:223], v[132:135], v[72:75], a[220:223]
    v_mfma_f32_16x16x32_bf16 a[224:227], v[136:139], v[44:47], a[224:227]
    v_mfma_f32_16x16x32_bf16 a[228:231], v[136:139], v[48:51], a[228:231]
    v_mfma_f32_16x16x32_bf16 a[232:235], v[136:139], v[52:55], a[232:235]
    v_mfma_f32_16x16x32_bf16 a[236:239], v[136:139], v[56:59], a[236:239]
    v_mfma_f32_16x16x32_bf16 a[240:243], v[136:139], v[60:63], a[240:243]
    v_mfma_f32_16x16x32_bf16 a[244:247], v[136:139], v[64:67], a[244:247]
    v_mfma_f32_16x16x32_bf16 a[248:251], v[136:139], v[68:71], a[248:251]
    v_mfma_f32_16x16x32_bf16 a[252:255], v[136:139], v[72:75], a[252:255]
    v_mfma_f32_16x16x32_bf16 a[0:3], v[140:143], v[76:79], a[0:3]
    v_mfma_f32_16x16x32_bf16 a[4:7], v[140:143], v[80:83], a[4:7]
    v_mfma_f32_16x16x32_bf16 a[8:11], v[140:143], v[84:87], a[8:11]
    v_mfma_f32_16x16x32_bf16 a[12:15], v[140:143], v[88:91], a[12:15]
    s_waitcnt lgkmcnt(0)
    s_waitcnt vmcnt(0)
    s_barrier
    v_mfma_f32_16x16x32_bf16 a[16:19], v[140:143], v[92:95], a[16:19]
    ds_read_b64_tr_b16 v[108:109], v10 offset:32768
    v_mfma_f32_16x16x32_bf16 a[20:23], v[140:143], v[96:99], a[20:23]
    ds_read_b64_tr_b16 v[110:111], v10 offset:34816
    v_mfma_f32_16x16x32_bf16 a[24:27], v[140:143], v[100:103], a[24:27]
    ds_read_b128 v[44:47], v8 offset:32768
    v_mfma_f32_16x16x32_bf16 a[28:31], v[140:143], v[104:107], a[28:31]
    ds_read_b128 v[48:51], v8 offset:34816
    v_mfma_f32_16x16x32_bf16 a[32:35], v[144:147], v[76:79], a[32:35]
    ds_read_b128 v[52:55], v8 offset:36864
    v_mfma_f32_16x16x32_bf16 a[36:39], v[144:147], v[80:83], a[36:39]
    ds_read_b128 v[56:59], v8 offset:38912
    v_mfma_f32_16x16x32_bf16 a[40:43], v[144:147], v[84:87], a[40:43]
    ds_read_b128 v[60:63], v8 offset:40960
    v_mfma_f32_16x16x32_bf16 a[44:47], v[144:147], v[88:91], a[44:47]
    ds_read_b128 v[64:67], v8 offset:43008
    v_mfma_f32_16x16x32_bf16 a[48:51], v[144:147], v[92:95], a[48:51]
    ds_read_b128 v[68:71], v8 offset:45056
    v_mfma_f32_16x16x32_bf16 a[52:55], v[144:147], v[96:99], a[52:55]
    ds_read_b128 v[72:75], v8 offset:47104
    v_mfma_f32_16x16x32_bf16 a[56:59], v[144:147], v[100:103], a[56:59]
    ds_read_b64_tr_b16 v[112:113], v11 offset:32768
    v_mfma_f32_16x16x32_bf16 a[60:63], v[144:147], v[104:107], a[60:63]
    ds_read_b64_tr_b16 v[114:115], v11 offset:34816
    v_mfma_f32_16x16x32_bf16 a[64:67], v[148:151], v[76:79], a[64:67]
    ds_read_b64_tr_b16 v[116:117], v12 offset:32768
    v_mfma_f32_16x16x32_bf16 a[68:71], v[148:151], v[80:83], a[68:71]
    ds_read_b64_tr_b16 v[118:119], v12 offset:34816
    v_mfma_f32_16x16x32_bf16 a[72:75], v[148:151], v[84:87], a[72:75]
    ds_read_b64_tr_b16 v[120:121], v13 offset:32768
    v_mfma_f32_16x16x32_bf16 a[76:79], v[148:151], v[88:91], a[76:79]
    ds_read_b64_tr_b16 v[122:123], v13 offset:34816
    v_mfma_f32_16x16x32_bf16 a[80:83], v[148:151], v[92:95], a[80:83]
    ds_read_b64_tr_b16 v[124:125], v14 offset:32768
    v_mfma_f32_16x16x32_bf16 a[84:87], v[148:151], v[96:99], a[84:87]
    ds_read_b64_tr_b16 v[126:127], v14 offset:34816
    v_mfma_f32_16x16x32_bf16 a[88:91], v[148:151], v[100:103], a[88:91]
    ds_read_b64_tr_b16 v[128:129], v15 offset:32768
    v_mfma_f32_16x16x32_bf16 a[92:95], v[148:151], v[104:107], a[92:95]
    ds_read_b64_tr_b16 v[130:131], v15 offset:34816
    v_mfma_f32_16x16x32_bf16 a[96:99], v[152:155], v[76:79], a[96:99]
    ds_read_b64_tr_b16 v[132:133], v16 offset:32768
    v_mfma_f32_16x16x32_bf16 a[100:103], v[152:155], v[80:83], a[100:103]
    ds_read_b64_tr_b16 v[134:135], v16 offset:34816
    v_mfma_f32_16x16x32_bf16 a[104:107], v[152:155], v[84:87], a[104:107]
    ds_read_b64_tr_b16 v[136:137], v17 offset:32768
    v_mfma_f32_16x16x32_bf16 a[108:111], v[152:155], v[88:91], a[108:111]
    ds_read_b64_tr_b16 v[138:139], v17 offset:34816
    v_mfma_f32_16x16x32_bf16 a[112:115], v[152:155], v[92:95], a[112:115]
    v_mfma_f32_16x16x32_bf16 a[116:119], v[152:155], v[96:99], a[116:119]
    v_mfma_f32_16x16x32_bf16 a[120:123], v[152:155], v[100:103], a[120:123]
    v_mfma_f32_16x16x32_bf16 a[124:127], v[152:155], v[104:107], a[124:127]
    v_mfma_f32_16x16x32_bf16 a[128:131], v[156:159], v[76:79], a[128:131]
    v_mfma_f32_16x16x32_bf16 a[132:135], v[156:159], v[80:83], a[132:135]
    v_mfma_f32_16x16x32_bf16 a[136:139], v[156:159], v[84:87], a[136:139]
    v_mfma_f32_16x16x32_bf16 a[140:143], v[156:159], v[88:91], a[140:143]
    v_mfma_f32_16x16x32_bf16 a[144:147], v[156:159], v[92:95], a[144:147]
    v_mfma_f32_16x16x32_bf16 a[148:151], v[156:159], v[96:99], a[148:151]
    v_mfma_f32_16x16x32_bf16 a[152:155], v[156:159], v[100:103], a[152:155]
    v_mfma_f32_16x16x32_bf16 a[156:159], v[156:159], v[104:107], a[156:159]
    v_mfma_f32_16x16x32_bf16 a[160:163], v[160:163], v[76:79], a[160:163]
    v_mfma_f32_16x16x32_bf16 a[164:167], v[160:163], v[80:83], a[164:167]
    v_mfma_f32_16x16x32_bf16 a[168:171], v[160:163], v[84:87], a[168:171]
    v_mfma_f32_16x16x32_bf16 a[172:175], v[160:163], v[88:91], a[172:175]
    v_mfma_f32_16x16x32_bf16 a[176:179], v[160:163], v[92:95], a[176:179]
    v_mfma_f32_16x16x32_bf16 a[180:183], v[160:163], v[96:99], a[180:183]
    v_mfma_f32_16x16x32_bf16 a[184:187], v[160:163], v[100:103], a[184:187]
    v_mfma_f32_16x16x32_bf16 a[188:191], v[160:163], v[104:107], a[188:191]
    v_mfma_f32_16x16x32_bf16 a[192:195], v[164:167], v[76:79], a[192:195]
    v_mfma_f32_16x16x32_bf16 a[196:199], v[164:167], v[80:83], a[196:199]
    v_mfma_f32_16x16x32_bf16 a[200:203], v[164:167], v[84:87], a[200:203]
    v_mfma_f32_16x16x32_bf16 a[204:207], v[164:167], v[88:91], a[204:207]
    v_mfma_f32_16x16x32_bf16 a[208:211], v[164:167], v[92:95], a[208:211]
    v_mfma_f32_16x16x32_bf16 a[212:215], v[164:167], v[96:99], a[212:215]
    v_mfma_f32_16x16x32_bf16 a[216:219], v[164:167], v[100:103], a[216:219]
    v_mfma_f32_16x16x32_bf16 a[220:223], v[164:167], v[104:107], a[220:223]
    v_mfma_f32_16x16x32_bf16 a[224:227], v[168:171], v[76:79], a[224:227]
    v_mfma_f32_16x16x32_bf16 a[228:231], v[168:171], v[80:83], a[228:231]
    v_mfma_f32_16x16x32_bf16 a[232:235], v[168:171], v[84:87], a[232:235]
    v_mfma_f32_16x16x32_bf16 a[236:239], v[168:171], v[88:91], a[236:239]
    v_mfma_f32_16x16x32_bf16 a[240:243], v[168:171], v[92:95], a[240:243]
    v_mfma_f32_16x16x32_bf16 a[244:247], v[168:171], v[96:99], a[244:247]
    v_mfma_f32_16x16x32_bf16 a[248:251], v[168:171], v[100:103], a[248:251]
    v_mfma_f32_16x16x32_bf16 a[252:255], v[168:171], v[104:107], a[252:255]
    s_waitcnt lgkmcnt(15)
    v_mfma_f32_16x16x32_bf16 a[0:3], v[108:111], v[44:47], a[0:3]
    ds_read_b64_tr_b16 v[140:141], v10 offset:49152
    v_mfma_f32_16x16x32_bf16 a[4:7], v[108:111], v[48:51], a[4:7]
    ds_read_b64_tr_b16 v[142:143], v10 offset:51200
    v_mfma_f32_16x16x32_bf16 a[8:11], v[108:111], v[52:55], a[8:11]
    ds_read_b128 v[76:79], v9 offset:32768
    v_mfma_f32_16x16x32_bf16 a[12:15], v[108:111], v[56:59], a[12:15]
    ds_read_b128 v[80:83], v9 offset:34816
    v_mfma_f32_16x16x32_bf16 a[16:19], v[108:111], v[60:63], a[16:19]
    ds_read_b128 v[84:87], v9 offset:36864
    v_mfma_f32_16x16x32_bf16 a[20:23], v[108:111], v[64:67], a[20:23]
    ds_read_b128 v[88:91], v9 offset:38912
    v_mfma_f32_16x16x32_bf16 a[24:27], v[108:111], v[68:71], a[24:27]
    ds_read_b128 v[92:95], v9 offset:40960
    s_waitcnt lgkmcnt(15)
    v_mfma_f32_16x16x32_bf16 a[28:31], v[108:111], v[72:75], a[28:31]
    ds_read_b128 v[96:99], v9 offset:43008
    v_mfma_f32_16x16x32_bf16 a[32:35], v[112:115], v[44:47], a[32:35]
    ds_read_b128 v[100:103], v9 offset:45056
    v_mfma_f32_16x16x32_bf16 a[36:39], v[112:115], v[48:51], a[36:39]
    ds_read_b128 v[104:107], v9 offset:47104
    v_mfma_f32_16x16x32_bf16 a[40:43], v[112:115], v[52:55], a[40:43]
    ds_read_b64_tr_b16 v[144:145], v11 offset:49152
    v_mfma_f32_16x16x32_bf16 a[44:47], v[112:115], v[56:59], a[44:47]
    ds_read_b64_tr_b16 v[146:147], v11 offset:51200
    v_mfma_f32_16x16x32_bf16 a[48:51], v[112:115], v[60:63], a[48:51]
    ds_read_b64_tr_b16 v[148:149], v12 offset:49152
    v_mfma_f32_16x16x32_bf16 a[52:55], v[112:115], v[64:67], a[52:55]
    ds_read_b64_tr_b16 v[150:151], v12 offset:51200
    v_mfma_f32_16x16x32_bf16 a[56:59], v[112:115], v[68:71], a[56:59]
    ds_read_b64_tr_b16 v[152:153], v13 offset:49152
    v_mfma_f32_16x16x32_bf16 a[60:63], v[112:115], v[72:75], a[60:63]
    ds_read_b64_tr_b16 v[154:155], v13 offset:51200
    v_mfma_f32_16x16x32_bf16 a[64:67], v[116:119], v[44:47], a[64:67]
    ds_read_b64_tr_b16 v[156:157], v14 offset:49152
    v_mfma_f32_16x16x32_bf16 a[68:71], v[116:119], v[48:51], a[68:71]
    ds_read_b64_tr_b16 v[158:159], v14 offset:51200
    v_mfma_f32_16x16x32_bf16 a[72:75], v[116:119], v[52:55], a[72:75]
    ds_read_b64_tr_b16 v[160:161], v15 offset:49152
    v_mfma_f32_16x16x32_bf16 a[76:79], v[116:119], v[56:59], a[76:79]
    ds_read_b64_tr_b16 v[162:163], v15 offset:51200
    v_mfma_f32_16x16x32_bf16 a[80:83], v[116:119], v[60:63], a[80:83]
    ds_read_b64_tr_b16 v[164:165], v16 offset:49152
    v_mfma_f32_16x16x32_bf16 a[84:87], v[116:119], v[64:67], a[84:87]
    ds_read_b64_tr_b16 v[166:167], v16 offset:51200
    v_mfma_f32_16x16x32_bf16 a[88:91], v[116:119], v[68:71], a[88:91]
    ds_read_b64_tr_b16 v[168:169], v17 offset:49152
    v_mfma_f32_16x16x32_bf16 a[92:95], v[116:119], v[72:75], a[92:95]
    ds_read_b64_tr_b16 v[170:171], v17 offset:51200
    v_mfma_f32_16x16x32_bf16 a[96:99], v[120:123], v[44:47], a[96:99]
    v_mfma_f32_16x16x32_bf16 a[100:103], v[120:123], v[48:51], a[100:103]
    v_mfma_f32_16x16x32_bf16 a[104:107], v[120:123], v[52:55], a[104:107]
    v_mfma_f32_16x16x32_bf16 a[108:111], v[120:123], v[56:59], a[108:111]
    v_mfma_f32_16x16x32_bf16 a[112:115], v[120:123], v[60:63], a[112:115]
    v_mfma_f32_16x16x32_bf16 a[116:119], v[120:123], v[64:67], a[116:119]
    v_mfma_f32_16x16x32_bf16 a[120:123], v[120:123], v[68:71], a[120:123]
    v_mfma_f32_16x16x32_bf16 a[124:127], v[120:123], v[72:75], a[124:127]
    s_waitcnt lgkmcnt(15)
    v_mfma_f32_16x16x32_bf16 a[128:131], v[124:127], v[44:47], a[128:131]
    v_mfma_f32_16x16x32_bf16 a[132:135], v[124:127], v[48:51], a[132:135]
    v_mfma_f32_16x16x32_bf16 a[136:139], v[124:127], v[52:55], a[136:139]
    v_mfma_f32_16x16x32_bf16 a[140:143], v[124:127], v[56:59], a[140:143]
    v_mfma_f32_16x16x32_bf16 a[144:147], v[124:127], v[60:63], a[144:147]
    v_mfma_f32_16x16x32_bf16 a[148:151], v[124:127], v[64:67], a[148:151]
    v_mfma_f32_16x16x32_bf16 a[152:155], v[124:127], v[68:71], a[152:155]
    v_mfma_f32_16x16x32_bf16 a[156:159], v[124:127], v[72:75], a[156:159]
    v_mfma_f32_16x16x32_bf16 a[160:163], v[128:131], v[44:47], a[160:163]
    v_mfma_f32_16x16x32_bf16 a[164:167], v[128:131], v[48:51], a[164:167]
    v_mfma_f32_16x16x32_bf16 a[168:171], v[128:131], v[52:55], a[168:171]
    v_mfma_f32_16x16x32_bf16 a[172:175], v[128:131], v[56:59], a[172:175]
    v_mfma_f32_16x16x32_bf16 a[176:179], v[128:131], v[60:63], a[176:179]
    v_mfma_f32_16x16x32_bf16 a[180:183], v[128:131], v[64:67], a[180:183]
    v_mfma_f32_16x16x32_bf16 a[184:187], v[128:131], v[68:71], a[184:187]
    v_mfma_f32_16x16x32_bf16 a[188:191], v[128:131], v[72:75], a[188:191]
    v_mfma_f32_16x16x32_bf16 a[192:195], v[132:135], v[44:47], a[192:195]
    v_mfma_f32_16x16x32_bf16 a[196:199], v[132:135], v[48:51], a[196:199]
    v_mfma_f32_16x16x32_bf16 a[200:203], v[132:135], v[52:55], a[200:203]
    v_mfma_f32_16x16x32_bf16 a[204:207], v[132:135], v[56:59], a[204:207]
    v_mfma_f32_16x16x32_bf16 a[208:211], v[132:135], v[60:63], a[208:211]
    v_mfma_f32_16x16x32_bf16 a[212:215], v[132:135], v[64:67], a[212:215]
    v_mfma_f32_16x16x32_bf16 a[216:219], v[132:135], v[68:71], a[216:219]
    v_mfma_f32_16x16x32_bf16 a[220:223], v[132:135], v[72:75], a[220:223]
    v_mfma_f32_16x16x32_bf16 a[224:227], v[136:139], v[44:47], a[224:227]
    v_mfma_f32_16x16x32_bf16 a[228:231], v[136:139], v[48:51], a[228:231]
    v_mfma_f32_16x16x32_bf16 a[232:235], v[136:139], v[52:55], a[232:235]
    v_mfma_f32_16x16x32_bf16 a[236:239], v[136:139], v[56:59], a[236:239]
    v_mfma_f32_16x16x32_bf16 a[240:243], v[136:139], v[60:63], a[240:243]
    v_mfma_f32_16x16x32_bf16 a[244:247], v[136:139], v[64:67], a[244:247]
    v_mfma_f32_16x16x32_bf16 a[248:251], v[136:139], v[68:71], a[248:251]
    v_mfma_f32_16x16x32_bf16 a[252:255], v[136:139], v[72:75], a[252:255]
    v_mfma_f32_16x16x32_bf16 a[0:3], v[140:143], v[76:79], a[0:3]
    v_mfma_f32_16x16x32_bf16 a[4:7], v[140:143], v[80:83], a[4:7]
    v_mfma_f32_16x16x32_bf16 a[8:11], v[140:143], v[84:87], a[8:11]
    v_mfma_f32_16x16x32_bf16 a[12:15], v[140:143], v[88:91], a[12:15]
    v_mfma_f32_16x16x32_bf16 a[16:19], v[140:143], v[92:95], a[16:19]
    v_mfma_f32_16x16x32_bf16 a[20:23], v[140:143], v[96:99], a[20:23]
    v_mfma_f32_16x16x32_bf16 a[24:27], v[140:143], v[100:103], a[24:27]
    s_waitcnt lgkmcnt(14)
    v_mfma_f32_16x16x32_bf16 a[28:31], v[140:143], v[104:107], a[28:31]
    s_waitcnt lgkmcnt(12)
    v_mfma_f32_16x16x32_bf16 a[32:35], v[144:147], v[76:79], a[32:35]
    v_mfma_f32_16x16x32_bf16 a[36:39], v[144:147], v[80:83], a[36:39]
    v_mfma_f32_16x16x32_bf16 a[40:43], v[144:147], v[84:87], a[40:43]
    v_mfma_f32_16x16x32_bf16 a[44:47], v[144:147], v[88:91], a[44:47]
    v_mfma_f32_16x16x32_bf16 a[48:51], v[144:147], v[92:95], a[48:51]
    v_mfma_f32_16x16x32_bf16 a[52:55], v[144:147], v[96:99], a[52:55]
    v_mfma_f32_16x16x32_bf16 a[56:59], v[144:147], v[100:103], a[56:59]
    v_mfma_f32_16x16x32_bf16 a[60:63], v[144:147], v[104:107], a[60:63]
    s_waitcnt lgkmcnt(10)
    v_mfma_f32_16x16x32_bf16 a[64:67], v[148:151], v[76:79], a[64:67]
    v_mfma_f32_16x16x32_bf16 a[68:71], v[148:151], v[80:83], a[68:71]
    v_mfma_f32_16x16x32_bf16 a[72:75], v[148:151], v[84:87], a[72:75]
    v_mfma_f32_16x16x32_bf16 a[76:79], v[148:151], v[88:91], a[76:79]
    v_mfma_f32_16x16x32_bf16 a[80:83], v[148:151], v[92:95], a[80:83]
    v_mfma_f32_16x16x32_bf16 a[84:87], v[148:151], v[96:99], a[84:87]
    v_mfma_f32_16x16x32_bf16 a[88:91], v[148:151], v[100:103], a[88:91]
    v_mfma_f32_16x16x32_bf16 a[92:95], v[148:151], v[104:107], a[92:95]
    s_waitcnt lgkmcnt(8)
    v_mfma_f32_16x16x32_bf16 a[96:99], v[152:155], v[76:79], a[96:99]
    v_mfma_f32_16x16x32_bf16 a[100:103], v[152:155], v[80:83], a[100:103]
    v_mfma_f32_16x16x32_bf16 a[104:107], v[152:155], v[84:87], a[104:107]
    v_mfma_f32_16x16x32_bf16 a[108:111], v[152:155], v[88:91], a[108:111]
    v_mfma_f32_16x16x32_bf16 a[112:115], v[152:155], v[92:95], a[112:115]
    v_mfma_f32_16x16x32_bf16 a[116:119], v[152:155], v[96:99], a[116:119]
    v_mfma_f32_16x16x32_bf16 a[120:123], v[152:155], v[100:103], a[120:123]
    v_mfma_f32_16x16x32_bf16 a[124:127], v[152:155], v[104:107], a[124:127]
    s_waitcnt lgkmcnt(6)
    v_mfma_f32_16x16x32_bf16 a[128:131], v[156:159], v[76:79], a[128:131]
    v_mfma_f32_16x16x32_bf16 a[132:135], v[156:159], v[80:83], a[132:135]
    v_mfma_f32_16x16x32_bf16 a[136:139], v[156:159], v[84:87], a[136:139]
    v_mfma_f32_16x16x32_bf16 a[140:143], v[156:159], v[88:91], a[140:143]
    v_mfma_f32_16x16x32_bf16 a[144:147], v[156:159], v[92:95], a[144:147]
    v_mfma_f32_16x16x32_bf16 a[148:151], v[156:159], v[96:99], a[148:151]
    v_mfma_f32_16x16x32_bf16 a[152:155], v[156:159], v[100:103], a[152:155]
    v_mfma_f32_16x16x32_bf16 a[156:159], v[156:159], v[104:107], a[156:159]
    s_waitcnt lgkmcnt(4)
    v_mfma_f32_16x16x32_bf16 a[160:163], v[160:163], v[76:79], a[160:163]
    v_mfma_f32_16x16x32_bf16 a[164:167], v[160:163], v[80:83], a[164:167]
    v_mfma_f32_16x16x32_bf16 a[168:171], v[160:163], v[84:87], a[168:171]
    v_mfma_f32_16x16x32_bf16 a[172:175], v[160:163], v[88:91], a[172:175]
    v_mfma_f32_16x16x32_bf16 a[176:179], v[160:163], v[92:95], a[176:179]
    v_mfma_f32_16x16x32_bf16 a[180:183], v[160:163], v[96:99], a[180:183]
    v_mfma_f32_16x16x32_bf16 a[184:187], v[160:163], v[100:103], a[184:187]
    v_mfma_f32_16x16x32_bf16 a[188:191], v[160:163], v[104:107], a[188:191]
    s_waitcnt lgkmcnt(2)
    v_mfma_f32_16x16x32_bf16 a[192:195], v[164:167], v[76:79], a[192:195]
    v_mfma_f32_16x16x32_bf16 a[196:199], v[164:167], v[80:83], a[196:199]
    v_mfma_f32_16x16x32_bf16 a[200:203], v[164:167], v[84:87], a[200:203]
    v_mfma_f32_16x16x32_bf16 a[204:207], v[164:167], v[88:91], a[204:207]
    v_mfma_f32_16x16x32_bf16 a[208:211], v[164:167], v[92:95], a[208:211]
    v_mfma_f32_16x16x32_bf16 a[212:215], v[164:167], v[96:99], a[212:215]
    v_mfma_f32_16x16x32_bf16 a[216:219], v[164:167], v[100:103], a[216:219]
    v_mfma_f32_16x16x32_bf16 a[220:223], v[164:167], v[104:107], a[220:223]
    s_waitcnt lgkmcnt(0)
    v_mfma_f32_16x16x32_bf16 a[224:227], v[168:171], v[76:79], a[224:227]
    v_mfma_f32_16x16x32_bf16 a[228:231], v[168:171], v[80:83], a[228:231]
    v_mfma_f32_16x16x32_bf16 a[232:235], v[168:171], v[84:87], a[232:235]
    v_mfma_f32_16x16x32_bf16 a[236:239], v[168:171], v[88:91], a[236:239]
    v_mfma_f32_16x16x32_bf16 a[240:243], v[168:171], v[92:95], a[240:243]
    v_mfma_f32_16x16x32_bf16 a[244:247], v[168:171], v[96:99], a[244:247]
    v_mfma_f32_16x16x32_bf16 a[248:251], v[168:171], v[100:103], a[248:251]
    v_mfma_f32_16x16x32_bf16 a[252:255], v[168:171], v[104:107], a[252:255]
    v_accvgpr_read_b32 v44, a0
    v_accvgpr_read_b32 v45, a1
    v_accvgpr_read_b32 v46, a2
    v_accvgpr_read_b32 v47, a3
    v_accvgpr_read_b32 v48, a32
    v_accvgpr_read_b32 v49, a33
    v_accvgpr_read_b32 v50, a34
    v_accvgpr_read_b32 v51, a35
    v_cvt_pk_bf16_f32 v52, v44, v45
    v_cvt_pk_bf16_f32 v53, v46, v47
    v_cvt_pk_bf16_f32 v54, v48, v49
    v_cvt_pk_bf16_f32 v55, v50, v51
    v_pk_max_i16 v52, v52, s28
    v_pk_max_i16 v53, v53, s28
    v_pk_max_i16 v54, v54, s28
    v_pk_max_i16 v55, v55, s28
    s_nop 0
    v_permlane16_swap_b32 v52, v54
    v_permlane16_swap_b32 v53, v55
    buffer_store_dwordx4 v[52:55], v34, s[12:15], s27 offen offset:0
    v_accvgpr_read_b32 v56, a4
    v_accvgpr_read_b32 v57, a5
    v_accvgpr_read_b32 v58, a6
    v_accvgpr_read_b32 v59, a7
    v_accvgpr_read_b32 v60, a36
    v_accvgpr_read_b32 v61, a37
    v_accvgpr_read_b32 v62, a38
    v_accvgpr_read_b32 v63, a39
    v_cvt_pk_bf16_f32 v64, v56, v57
    v_cvt_pk_bf16_f32 v65, v58, v59
    v_cvt_pk_bf16_f32 v66, v60, v61
    v_cvt_pk_bf16_f32 v67, v62, v63
    v_pk_max_i16 v64, v64, s28
    v_pk_max_i16 v65, v65, s28
    v_pk_max_i16 v66, v66, s28
    v_pk_max_i16 v67, v67, s28
    s_nop 0
    v_permlane16_swap_b32 v64, v66
    v_permlane16_swap_b32 v65, v67
    buffer_store_dwordx4 v[64:67], v35, s[12:15], s27 offen offset:0
    v_accvgpr_read_b32 v68, a8
    v_accvgpr_read_b32 v69, a9
    v_accvgpr_read_b32 v70, a10
    v_accvgpr_read_b32 v71, a11
    v_accvgpr_read_b32 v72, a40
    v_accvgpr_read_b32 v73, a41
    v_accvgpr_read_b32 v74, a42
    v_accvgpr_read_b32 v75, a43
    v_cvt_pk_bf16_f32 v76, v68, v69
    v_cvt_pk_bf16_f32 v77, v70, v71
    v_cvt_pk_bf16_f32 v78, v72, v73
    v_cvt_pk_bf16_f32 v79, v74, v75
    v_pk_max_i16 v76, v76, s28
    v_pk_max_i16 v77, v77, s28
    v_pk_max_i16 v78, v78, s28
    v_pk_max_i16 v79, v79, s28
    s_nop 0
    v_permlane16_swap_b32 v76, v78
    v_permlane16_swap_b32 v77, v79
    buffer_store_dwordx4 v[76:79], v36, s[12:15], s27 offen offset:0
    v_accvgpr_read_b32 v80, a12
    v_accvgpr_read_b32 v81, a13
    v_accvgpr_read_b32 v82, a14
    v_accvgpr_read_b32 v83, a15
    v_accvgpr_read_b32 v84, a44
    v_accvgpr_read_b32 v85, a45
    v_accvgpr_read_b32 v86, a46
    v_accvgpr_read_b32 v87, a47
    v_cvt_pk_bf16_f32 v88, v80, v81
    v_cvt_pk_bf16_f32 v89, v82, v83
    v_cvt_pk_bf16_f32 v90, v84, v85
    v_cvt_pk_bf16_f32 v91, v86, v87
    v_pk_max_i16 v88, v88, s28
    v_pk_max_i16 v89, v89, s28
    v_pk_max_i16 v90, v90, s28
    v_pk_max_i16 v91, v91, s28
    s_nop 0
    v_permlane16_swap_b32 v88, v90
    v_permlane16_swap_b32 v89, v91
    buffer_store_dwordx4 v[88:91], v37, s[12:15], s27 offen offset:0
    v_accvgpr_read_b32 v44, a16
    v_accvgpr_read_b32 v45, a17
    v_accvgpr_read_b32 v46, a18
    v_accvgpr_read_b32 v47, a19
    v_accvgpr_read_b32 v48, a48
    v_accvgpr_read_b32 v49, a49
    v_accvgpr_read_b32 v50, a50
    v_accvgpr_read_b32 v51, a51
    v_cvt_pk_bf16_f32 v52, v44, v45
    v_cvt_pk_bf16_f32 v53, v46, v47
    v_cvt_pk_bf16_f32 v54, v48, v49
    v_cvt_pk_bf16_f32 v55, v50, v51
    v_pk_max_i16 v52, v52, s28
    v_pk_max_i16 v53, v53, s28
    v_pk_max_i16 v54, v54, s28
    v_pk_max_i16 v55, v55, s28
    s_nop 0
    v_permlane16_swap_b32 v52, v54
    v_permlane16_swap_b32 v53, v55
    buffer_store_dwordx4 v[52:55], v38, s[12:15], s27 offen offset:0
    v_accvgpr_read_b32 v56, a20
    v_accvgpr_read_b32 v57, a21
    v_accvgpr_read_b32 v58, a22
    v_accvgpr_read_b32 v59, a23
    v_accvgpr_read_b32 v60, a52
    v_accvgpr_read_b32 v61, a53
    v_accvgpr_read_b32 v62, a54
    v_accvgpr_read_b32 v63, a55
    v_cvt_pk_bf16_f32 v64, v56, v57
    v_cvt_pk_bf16_f32 v65, v58, v59
    v_cvt_pk_bf16_f32 v66, v60, v61
    v_cvt_pk_bf16_f32 v67, v62, v63
    v_pk_max_i16 v64, v64, s28
    v_pk_max_i16 v65, v65, s28
    v_pk_max_i16 v66, v66, s28
    v_pk_max_i16 v67, v67, s28
    s_nop 0
    v_permlane16_swap_b32 v64, v66
    v_permlane16_swap_b32 v65, v67
    buffer_store_dwordx4 v[64:67], v39, s[12:15], s27 offen offset:0
    v_accvgpr_read_b32 v68, a24
    v_accvgpr_read_b32 v69, a25
    v_accvgpr_read_b32 v70, a26
    v_accvgpr_read_b32 v71, a27
    v_accvgpr_read_b32 v72, a56
    v_accvgpr_read_b32 v73, a57
    v_accvgpr_read_b32 v74, a58
    v_accvgpr_read_b32 v75, a59
    v_cvt_pk_bf16_f32 v76, v68, v69
    v_cvt_pk_bf16_f32 v77, v70, v71
    v_cvt_pk_bf16_f32 v78, v72, v73
    v_cvt_pk_bf16_f32 v79, v74, v75
    v_pk_max_i16 v76, v76, s28
    v_pk_max_i16 v77, v77, s28
    v_pk_max_i16 v78, v78, s28
    v_pk_max_i16 v79, v79, s28
    s_nop 0
    v_permlane16_swap_b32 v76, v78
    v_permlane16_swap_b32 v77, v79
    buffer_store_dwordx4 v[76:79], v40, s[12:15], s27 offen offset:0
    v_accvgpr_read_b32 v80, a28
    v_accvgpr_read_b32 v81, a29
    v_accvgpr_read_b32 v82, a30
    v_accvgpr_read_b32 v83, a31
    v_accvgpr_read_b32 v84, a60
    v_accvgpr_read_b32 v85, a61
    v_accvgpr_read_b32 v86, a62
    v_accvgpr_read_b32 v87, a63
    v_cvt_pk_bf16_f32 v88, v80, v81
    v_cvt_pk_bf16_f32 v89, v82, v83
    v_cvt_pk_bf16_f32 v90, v84, v85
    v_cvt_pk_bf16_f32 v91, v86, v87
    v_pk_max_i16 v88, v88, s28
    v_pk_max_i16 v89, v89, s28
    v_pk_max_i16 v90, v90, s28
    v_pk_max_i16 v91, v91, s28
    s_nop 0
    v_permlane16_swap_b32 v88, v90
    v_permlane16_swap_b32 v89, v91
    buffer_store_dwordx4 v[88:91], v41, s[12:15], s27 offen offset:0
    v_accvgpr_read_b32 v44, a64
    v_accvgpr_read_b32 v45, a65
    v_accvgpr_read_b32 v46, a66
    v_accvgpr_read_b32 v47, a67
    v_accvgpr_read_b32 v48, a96
    v_accvgpr_read_b32 v49, a97
    v_accvgpr_read_b32 v50, a98
    v_accvgpr_read_b32 v51, a99
    v_cvt_pk_bf16_f32 v52, v44, v45
    v_cvt_pk_bf16_f32 v53, v46, v47
    v_cvt_pk_bf16_f32 v54, v48, v49
    v_cvt_pk_bf16_f32 v55, v50, v51
    v_pk_max_i16 v52, v52, s28
    v_pk_max_i16 v53, v53, s28
    v_pk_max_i16 v54, v54, s28
    v_pk_max_i16 v55, v55, s28
    s_nop 0
    v_permlane16_swap_b32 v52, v54
    v_permlane16_swap_b32 v53, v55
    buffer_store_dwordx4 v[52:55], v34, s[12:15], s27 offen offset:64
    v_accvgpr_read_b32 v56, a68
    v_accvgpr_read_b32 v57, a69
    v_accvgpr_read_b32 v58, a70
    v_accvgpr_read_b32 v59, a71
    v_accvgpr_read_b32 v60, a100
    v_accvgpr_read_b32 v61, a101
    v_accvgpr_read_b32 v62, a102
    v_accvgpr_read_b32 v63, a103
    v_cvt_pk_bf16_f32 v64, v56, v57
    v_cvt_pk_bf16_f32 v65, v58, v59
    v_cvt_pk_bf16_f32 v66, v60, v61
    v_cvt_pk_bf16_f32 v67, v62, v63
    v_pk_max_i16 v64, v64, s28
    v_pk_max_i16 v65, v65, s28
    v_pk_max_i16 v66, v66, s28
    v_pk_max_i16 v67, v67, s28
    s_nop 0
    v_permlane16_swap_b32 v64, v66
    v_permlane16_swap_b32 v65, v67
    buffer_store_dwordx4 v[64:67], v35, s[12:15], s27 offen offset:64
    v_accvgpr_read_b32 v68, a72
    v_accvgpr_read_b32 v69, a73
    v_accvgpr_read_b32 v70, a74
    v_accvgpr_read_b32 v71, a75
    v_accvgpr_read_b32 v72, a104
    v_accvgpr_read_b32 v73, a105
    v_accvgpr_read_b32 v74, a106
    v_accvgpr_read_b32 v75, a107
    v_cvt_pk_bf16_f32 v76, v68, v69
    v_cvt_pk_bf16_f32 v77, v70, v71
    v_cvt_pk_bf16_f32 v78, v72, v73
    v_cvt_pk_bf16_f32 v79, v74, v75
    v_pk_max_i16 v76, v76, s28
    v_pk_max_i16 v77, v77, s28
    v_pk_max_i16 v78, v78, s28
    v_pk_max_i16 v79, v79, s28
    s_nop 0
    v_permlane16_swap_b32 v76, v78
    v_permlane16_swap_b32 v77, v79
    buffer_store_dwordx4 v[76:79], v36, s[12:15], s27 offen offset:64
    v_accvgpr_read_b32 v80, a76
    v_accvgpr_read_b32 v81, a77
    v_accvgpr_read_b32 v82, a78
    v_accvgpr_read_b32 v83, a79
    v_accvgpr_read_b32 v84, a108
    v_accvgpr_read_b32 v85, a109
    v_accvgpr_read_b32 v86, a110
    v_accvgpr_read_b32 v87, a111
    v_cvt_pk_bf16_f32 v88, v80, v81
    v_cvt_pk_bf16_f32 v89, v82, v83
    v_cvt_pk_bf16_f32 v90, v84, v85
    v_cvt_pk_bf16_f32 v91, v86, v87
    v_pk_max_i16 v88, v88, s28
    v_pk_max_i16 v89, v89, s28
    v_pk_max_i16 v90, v90, s28
    v_pk_max_i16 v91, v91, s28
    s_nop 0
    v_permlane16_swap_b32 v88, v90
    v_permlane16_swap_b32 v89, v91
    buffer_store_dwordx4 v[88:91], v37, s[12:15], s27 offen offset:64
    v_accvgpr_read_b32 v44, a80
    v_accvgpr_read_b32 v45, a81
    v_accvgpr_read_b32 v46, a82
    v_accvgpr_read_b32 v47, a83
    v_accvgpr_read_b32 v48, a112
    v_accvgpr_read_b32 v49, a113
    v_accvgpr_read_b32 v50, a114
    v_accvgpr_read_b32 v51, a115
    v_cvt_pk_bf16_f32 v52, v44, v45
    v_cvt_pk_bf16_f32 v53, v46, v47
    v_cvt_pk_bf16_f32 v54, v48, v49
    v_cvt_pk_bf16_f32 v55, v50, v51
    v_pk_max_i16 v52, v52, s28
    v_pk_max_i16 v53, v53, s28
    v_pk_max_i16 v54, v54, s28
    v_pk_max_i16 v55, v55, s28
    s_nop 0
    v_permlane16_swap_b32 v52, v54
    v_permlane16_swap_b32 v53, v55
    buffer_store_dwordx4 v[52:55], v38, s[12:15], s27 offen offset:64
    v_accvgpr_read_b32 v56, a84
    v_accvgpr_read_b32 v57, a85
    v_accvgpr_read_b32 v58, a86
    v_accvgpr_read_b32 v59, a87
    v_accvgpr_read_b32 v60, a116
    v_accvgpr_read_b32 v61, a117
    v_accvgpr_read_b32 v62, a118
    v_accvgpr_read_b32 v63, a119
    v_cvt_pk_bf16_f32 v64, v56, v57
    v_cvt_pk_bf16_f32 v65, v58, v59
    v_cvt_pk_bf16_f32 v66, v60, v61
    v_cvt_pk_bf16_f32 v67, v62, v63
    v_pk_max_i16 v64, v64, s28
    v_pk_max_i16 v65, v65, s28
    v_pk_max_i16 v66, v66, s28
    v_pk_max_i16 v67, v67, s28
    s_nop 0
    v_permlane16_swap_b32 v64, v66
    v_permlane16_swap_b32 v65, v67
    buffer_store_dwordx4 v[64:67], v39, s[12:15], s27 offen offset:64
    v_accvgpr_read_b32 v68, a88
    v_accvgpr_read_b32 v69, a89
    v_accvgpr_read_b32 v70, a90
    v_accvgpr_read_b32 v71, a91
    v_accvgpr_read_b32 v72, a120
    v_accvgpr_read_b32 v73, a121
    v_accvgpr_read_b32 v74, a122
    v_accvgpr_read_b32 v75, a123
    v_cvt_pk_bf16_f32 v76, v68, v69
    v_cvt_pk_bf16_f32 v77, v70, v71
    v_cvt_pk_bf16_f32 v78, v72, v73
    v_cvt_pk_bf16_f32 v79, v74, v75
    v_pk_max_i16 v76, v76, s28
    v_pk_max_i16 v77, v77, s28
    v_pk_max_i16 v78, v78, s28
    v_pk_max_i16 v79, v79, s28
    s_nop 0
    v_permlane16_swap_b32 v76, v78
    v_permlane16_swap_b32 v77, v79
    buffer_store_dwordx4 v[76:79], v40, s[12:15], s27 offen offset:64
    v_accvgpr_read_b32 v80, a92
    v_accvgpr_read_b32 v81, a93
    v_accvgpr_read_b32 v82, a94
    v_accvgpr_read_b32 v83, a95
    v_accvgpr_read_b32 v84, a124
    v_accvgpr_read_b32 v85, a125
    v_accvgpr_read_b32 v86, a126
    v_accvgpr_read_b32 v87, a127
    v_cvt_pk_bf16_f32 v88, v80, v81
    v_cvt_pk_bf16_f32 v89, v82, v83
    v_cvt_pk_bf16_f32 v90, v84, v85
    v_cvt_pk_bf16_f32 v91, v86, v87
    v_pk_max_i16 v88, v88, s28
    v_pk_max_i16 v89, v89, s28
    v_pk_max_i16 v90, v90, s28
    v_pk_max_i16 v91, v91, s28
    s_nop 0
    v_permlane16_swap_b32 v88, v90
    v_permlane16_swap_b32 v89, v91
    buffer_store_dwordx4 v[88:91], v41, s[12:15], s27 offen offset:64
    v_accvgpr_read_b32 v44, a128
    v_accvgpr_read_b32 v45, a129
    v_accvgpr_read_b32 v46, a130
    v_accvgpr_read_b32 v47, a131
    v_accvgpr_read_b32 v48, a160
    v_accvgpr_read_b32 v49, a161
    v_accvgpr_read_b32 v50, a162
    v_accvgpr_read_b32 v51, a163
    v_cvt_pk_bf16_f32 v52, v44, v45
    v_cvt_pk_bf16_f32 v53, v46, v47
    v_cvt_pk_bf16_f32 v54, v48, v49
    v_cvt_pk_bf16_f32 v55, v50, v51
    v_pk_max_i16 v52, v52, s28
    v_pk_max_i16 v53, v53, s28
    v_pk_max_i16 v54, v54, s28
    v_pk_max_i16 v55, v55, s28
    s_nop 0
    v_permlane16_swap_b32 v52, v54
    v_permlane16_swap_b32 v53, v55
    buffer_store_dwordx4 v[52:55], v34, s[12:15], s27 offen offset:128
    v_accvgpr_read_b32 v56, a132
    v_accvgpr_read_b32 v57, a133
    v_accvgpr_read_b32 v58, a134
    v_accvgpr_read_b32 v59, a135
    v_accvgpr_read_b32 v60, a164
    v_accvgpr_read_b32 v61, a165
    v_accvgpr_read_b32 v62, a166
    v_accvgpr_read_b32 v63, a167
    v_cvt_pk_bf16_f32 v64, v56, v57
    v_cvt_pk_bf16_f32 v65, v58, v59
    v_cvt_pk_bf16_f32 v66, v60, v61
    v_cvt_pk_bf16_f32 v67, v62, v63
    v_pk_max_i16 v64, v64, s28
    v_pk_max_i16 v65, v65, s28
    v_pk_max_i16 v66, v66, s28
    v_pk_max_i16 v67, v67, s28
    s_nop 0
    v_permlane16_swap_b32 v64, v66
    v_permlane16_swap_b32 v65, v67
    buffer_store_dwordx4 v[64:67], v35, s[12:15], s27 offen offset:128
    v_accvgpr_read_b32 v68, a136
    v_accvgpr_read_b32 v69, a137
    v_accvgpr_read_b32 v70, a138
    v_accvgpr_read_b32 v71, a139
    v_accvgpr_read_b32 v72, a168
    v_accvgpr_read_b32 v73, a169
    v_accvgpr_read_b32 v74, a170
    v_accvgpr_read_b32 v75, a171
    v_cvt_pk_bf16_f32 v76, v68, v69
    v_cvt_pk_bf16_f32 v77, v70, v71
    v_cvt_pk_bf16_f32 v78, v72, v73
    v_cvt_pk_bf16_f32 v79, v74, v75
    v_pk_max_i16 v76, v76, s28
    v_pk_max_i16 v77, v77, s28
    v_pk_max_i16 v78, v78, s28
    v_pk_max_i16 v79, v79, s28
    s_nop 0
    v_permlane16_swap_b32 v76, v78
    v_permlane16_swap_b32 v77, v79
    buffer_store_dwordx4 v[76:79], v36, s[12:15], s27 offen offset:128
    v_accvgpr_read_b32 v80, a140
    v_accvgpr_read_b32 v81, a141
    v_accvgpr_read_b32 v82, a142
    v_accvgpr_read_b32 v83, a143
    v_accvgpr_read_b32 v84, a172
    v_accvgpr_read_b32 v85, a173
    v_accvgpr_read_b32 v86, a174
    v_accvgpr_read_b32 v87, a175
    v_cvt_pk_bf16_f32 v88, v80, v81
    v_cvt_pk_bf16_f32 v89, v82, v83
    v_cvt_pk_bf16_f32 v90, v84, v85
    v_cvt_pk_bf16_f32 v91, v86, v87
    v_pk_max_i16 v88, v88, s28
    v_pk_max_i16 v89, v89, s28
    v_pk_max_i16 v90, v90, s28
    v_pk_max_i16 v91, v91, s28
    s_nop 0
    v_permlane16_swap_b32 v88, v90
    v_permlane16_swap_b32 v89, v91
    buffer_store_dwordx4 v[88:91], v37, s[12:15], s27 offen offset:128
    v_accvgpr_read_b32 v44, a144
    v_accvgpr_read_b32 v45, a145
    v_accvgpr_read_b32 v46, a146
    v_accvgpr_read_b32 v47, a147
    v_accvgpr_read_b32 v48, a176
    v_accvgpr_read_b32 v49, a177
    v_accvgpr_read_b32 v50, a178
    v_accvgpr_read_b32 v51, a179
    v_cvt_pk_bf16_f32 v52, v44, v45
    v_cvt_pk_bf16_f32 v53, v46, v47
    v_cvt_pk_bf16_f32 v54, v48, v49
    v_cvt_pk_bf16_f32 v55, v50, v51
    v_pk_max_i16 v52, v52, s28
    v_pk_max_i16 v53, v53, s28
    v_pk_max_i16 v54, v54, s28
    v_pk_max_i16 v55, v55, s28
    s_nop 0
    v_permlane16_swap_b32 v52, v54
    v_permlane16_swap_b32 v53, v55
    buffer_store_dwordx4 v[52:55], v38, s[12:15], s27 offen offset:128
    v_accvgpr_read_b32 v56, a148
    v_accvgpr_read_b32 v57, a149
    v_accvgpr_read_b32 v58, a150
    v_accvgpr_read_b32 v59, a151
    v_accvgpr_read_b32 v60, a180
    v_accvgpr_read_b32 v61, a181
    v_accvgpr_read_b32 v62, a182
    v_accvgpr_read_b32 v63, a183
    v_cvt_pk_bf16_f32 v64, v56, v57
    v_cvt_pk_bf16_f32 v65, v58, v59
    v_cvt_pk_bf16_f32 v66, v60, v61
    v_cvt_pk_bf16_f32 v67, v62, v63
    v_pk_max_i16 v64, v64, s28
    v_pk_max_i16 v65, v65, s28
    v_pk_max_i16 v66, v66, s28
    v_pk_max_i16 v67, v67, s28
    s_nop 0
    v_permlane16_swap_b32 v64, v66
    v_permlane16_swap_b32 v65, v67
    buffer_store_dwordx4 v[64:67], v39, s[12:15], s27 offen offset:128
    v_accvgpr_read_b32 v68, a152
    v_accvgpr_read_b32 v69, a153
    v_accvgpr_read_b32 v70, a154
    v_accvgpr_read_b32 v71, a155
    v_accvgpr_read_b32 v72, a184
    v_accvgpr_read_b32 v73, a185
    v_accvgpr_read_b32 v74, a186
    v_accvgpr_read_b32 v75, a187
    v_cvt_pk_bf16_f32 v76, v68, v69
    v_cvt_pk_bf16_f32 v77, v70, v71
    v_cvt_pk_bf16_f32 v78, v72, v73
    v_cvt_pk_bf16_f32 v79, v74, v75
    v_pk_max_i16 v76, v76, s28
    v_pk_max_i16 v77, v77, s28
    v_pk_max_i16 v78, v78, s28
    v_pk_max_i16 v79, v79, s28
    s_nop 0
    v_permlane16_swap_b32 v76, v78
    v_permlane16_swap_b32 v77, v79
    buffer_store_dwordx4 v[76:79], v40, s[12:15], s27 offen offset:128
    v_accvgpr_read_b32 v80, a156
    v_accvgpr_read_b32 v81, a157
    v_accvgpr_read_b32 v82, a158
    v_accvgpr_read_b32 v83, a159
    v_accvgpr_read_b32 v84, a188
    v_accvgpr_read_b32 v85, a189
    v_accvgpr_read_b32 v86, a190
    v_accvgpr_read_b32 v87, a191
    v_cvt_pk_bf16_f32 v88, v80, v81
    v_cvt_pk_bf16_f32 v89, v82, v83
    v_cvt_pk_bf16_f32 v90, v84, v85
    v_cvt_pk_bf16_f32 v91, v86, v87
    v_pk_max_i16 v88, v88, s28
    v_pk_max_i16 v89, v89, s28
    v_pk_max_i16 v90, v90, s28
    v_pk_max_i16 v91, v91, s28
    s_nop 0
    v_permlane16_swap_b32 v88, v90
    v_permlane16_swap_b32 v89, v91
    buffer_store_dwordx4 v[88:91], v41, s[12:15], s27 offen offset:128
    v_accvgpr_read_b32 v44, a192
    v_accvgpr_read_b32 v45, a193
    v_accvgpr_read_b32 v46, a194
    v_accvgpr_read_b32 v47, a195
    v_accvgpr_read_b32 v48, a224
    v_accvgpr_read_b32 v49, a225
    v_accvgpr_read_b32 v50, a226
    v_accvgpr_read_b32 v51, a227
    v_cvt_pk_bf16_f32 v52, v44, v45
    v_cvt_pk_bf16_f32 v53, v46, v47
    v_cvt_pk_bf16_f32 v54, v48, v49
    v_cvt_pk_bf16_f32 v55, v50, v51
    v_pk_max_i16 v52, v52, s28
    v_pk_max_i16 v53, v53, s28
    v_pk_max_i16 v54, v54, s28
    v_pk_max_i16 v55, v55, s28
    s_nop 0
    v_permlane16_swap_b32 v52, v54
    v_permlane16_swap_b32 v53, v55
    buffer_store_dwordx4 v[52:55], v34, s[12:15], s27 offen offset:192
    v_accvgpr_read_b32 v56, a196
    v_accvgpr_read_b32 v57, a197
    v_accvgpr_read_b32 v58, a198
    v_accvgpr_read_b32 v59, a199
    v_accvgpr_read_b32 v60, a228
    v_accvgpr_read_b32 v61, a229
    v_accvgpr_read_b32 v62, a230
    v_accvgpr_read_b32 v63, a231
    v_cvt_pk_bf16_f32 v64, v56, v57
    v_cvt_pk_bf16_f32 v65, v58, v59
    v_cvt_pk_bf16_f32 v66, v60, v61
    v_cvt_pk_bf16_f32 v67, v62, v63
    v_pk_max_i16 v64, v64, s28
    v_pk_max_i16 v65, v65, s28
    v_pk_max_i16 v66, v66, s28
    v_pk_max_i16 v67, v67, s28
    s_nop 0
    v_permlane16_swap_b32 v64, v66
    v_permlane16_swap_b32 v65, v67
    buffer_store_dwordx4 v[64:67], v35, s[12:15], s27 offen offset:192
    v_accvgpr_read_b32 v68, a200
    v_accvgpr_read_b32 v69, a201
    v_accvgpr_read_b32 v70, a202
    v_accvgpr_read_b32 v71, a203
    v_accvgpr_read_b32 v72, a232
    v_accvgpr_read_b32 v73, a233
    v_accvgpr_read_b32 v74, a234
    v_accvgpr_read_b32 v75, a235
    v_cvt_pk_bf16_f32 v76, v68, v69
    v_cvt_pk_bf16_f32 v77, v70, v71
    v_cvt_pk_bf16_f32 v78, v72, v73
    v_cvt_pk_bf16_f32 v79, v74, v75
    v_pk_max_i16 v76, v76, s28
    v_pk_max_i16 v77, v77, s28
    v_pk_max_i16 v78, v78, s28
    v_pk_max_i16 v79, v79, s28
    s_nop 0
    v_permlane16_swap_b32 v76, v78
    v_permlane16_swap_b32 v77, v79
    buffer_store_dwordx4 v[76:79], v36, s[12:15], s27 offen offset:192
    v_accvgpr_read_b32 v80, a204
    v_accvgpr_read_b32 v81, a205
    v_accvgpr_read_b32 v82, a206
    v_accvgpr_read_b32 v83, a207
    v_accvgpr_read_b32 v84, a236
    v_accvgpr_read_b32 v85, a237
    v_accvgpr_read_b32 v86, a238
    v_accvgpr_read_b32 v87, a239
    v_cvt_pk_bf16_f32 v88, v80, v81
    v_cvt_pk_bf16_f32 v89, v82, v83
    v_cvt_pk_bf16_f32 v90, v84, v85
    v_cvt_pk_bf16_f32 v91, v86, v87
    v_pk_max_i16 v88, v88, s28
    v_pk_max_i16 v89, v89, s28
    v_pk_max_i16 v90, v90, s28
    v_pk_max_i16 v91, v91, s28
    s_nop 0
    v_permlane16_swap_b32 v88, v90
    v_permlane16_swap_b32 v89, v91
    buffer_store_dwordx4 v[88:91], v37, s[12:15], s27 offen offset:192
    v_accvgpr_read_b32 v44, a208
    v_accvgpr_read_b32 v45, a209
    v_accvgpr_read_b32 v46, a210
    v_accvgpr_read_b32 v47, a211
    v_accvgpr_read_b32 v48, a240
    v_accvgpr_read_b32 v49, a241
    v_accvgpr_read_b32 v50, a242
    v_accvgpr_read_b32 v51, a243
    v_cvt_pk_bf16_f32 v52, v44, v45
    v_cvt_pk_bf16_f32 v53, v46, v47
    v_cvt_pk_bf16_f32 v54, v48, v49
    v_cvt_pk_bf16_f32 v55, v50, v51
    v_pk_max_i16 v52, v52, s28
    v_pk_max_i16 v53, v53, s28
    v_pk_max_i16 v54, v54, s28
    v_pk_max_i16 v55, v55, s28
    s_nop 0
    v_permlane16_swap_b32 v52, v54
    v_permlane16_swap_b32 v53, v55
    buffer_store_dwordx4 v[52:55], v38, s[12:15], s27 offen offset:192
    v_accvgpr_read_b32 v56, a212
    v_accvgpr_read_b32 v57, a213
    v_accvgpr_read_b32 v58, a214
    v_accvgpr_read_b32 v59, a215
    v_accvgpr_read_b32 v60, a244
    v_accvgpr_read_b32 v61, a245
    v_accvgpr_read_b32 v62, a246
    v_accvgpr_read_b32 v63, a247
    v_cvt_pk_bf16_f32 v64, v56, v57
    v_cvt_pk_bf16_f32 v65, v58, v59
    v_cvt_pk_bf16_f32 v66, v60, v61
    v_cvt_pk_bf16_f32 v67, v62, v63
    v_pk_max_i16 v64, v64, s28
    v_pk_max_i16 v65, v65, s28
    v_pk_max_i16 v66, v66, s28
    v_pk_max_i16 v67, v67, s28
    s_nop 0
    v_permlane16_swap_b32 v64, v66
    v_permlane16_swap_b32 v65, v67
    buffer_store_dwordx4 v[64:67], v39, s[12:15], s27 offen offset:192
    v_accvgpr_read_b32 v68, a216
    v_accvgpr_read_b32 v69, a217
    v_accvgpr_read_b32 v70, a218
    v_accvgpr_read_b32 v71, a219
    v_accvgpr_read_b32 v72, a248
    v_accvgpr_read_b32 v73, a249
    v_accvgpr_read_b32 v74, a250
    v_accvgpr_read_b32 v75, a251
    v_cvt_pk_bf16_f32 v76, v68, v69
    v_cvt_pk_bf16_f32 v77, v70, v71
    v_cvt_pk_bf16_f32 v78, v72, v73
    v_cvt_pk_bf16_f32 v79, v74, v75
    v_pk_max_i16 v76, v76, s28
    v_pk_max_i16 v77, v77, s28
    v_pk_max_i16 v78, v78, s28
    v_pk_max_i16 v79, v79, s28
    s_nop 0
    v_permlane16_swap_b32 v76, v78
    v_permlane16_swap_b32 v77, v79
    buffer_store_dwordx4 v[76:79], v40, s[12:15], s27 offen offset:192
    v_accvgpr_read_b32 v80, a220
    v_accvgpr_read_b32 v81, a221
    v_accvgpr_read_b32 v82, a222
    v_accvgpr_read_b32 v83, a223
    v_accvgpr_read_b32 v84, a252
    v_accvgpr_read_b32 v85, a253
    v_accvgpr_read_b32 v86, a254
    v_accvgpr_read_b32 v87, a255
    v_cvt_pk_bf16_f32 v88, v80, v81
    v_cvt_pk_bf16_f32 v89, v82, v83
    v_cvt_pk_bf16_f32 v90, v84, v85
    v_cvt_pk_bf16_f32 v91, v86, v87
    v_pk_max_i16 v88, v88, s28
    v_pk_max_i16 v89, v89, s28
    v_pk_max_i16 v90, v90, s28
    v_pk_max_i16 v91, v91, s28
    s_nop 0
    v_permlane16_swap_b32 v88, v90
    v_permlane16_swap_b32 v89, v91
    buffer_store_dwordx4 v[88:91], v41, s[12:15], s27 offen offset:192
L_g1_end:
    s_endpgm
.section .rodata,"a"
.p2align 6
.amdhsa_kernel gemm1_kernel
  .amdhsa_next_free_vgpr 428
  .amdhsa_next_free_sgpr 49
  .amdhsa_accum_offset 172
  .amdhsa_group_segment_fixed_size 0
  .amdhsa_kernarg_size 88
  .amdhsa_user_sgpr_count 2
  .amdhsa_user_sgpr_kernarg_segment_ptr 1
  .amdhsa_system_sgpr_workgroup_id_x 1
.end_amdhsa_kernel
.text
.globl attn_kernel
.p2align 8
.type attn_kernel,@function
attn_kernel:
    s_load_dwordx2 s[32:33], s[0:1], 8
    s_load_dwordx2 s[34:35], s[0:1], 16
    s_load_dwordx2 s[36:37], s[0:1], 80
    s_load_dwordx2 s[48:49], s[0:1], 32
    s_load_dwordx2 s[50:51], s[0:1], 56
    s_cmp_ge_u32 s2, 512
    s_cbranch_scc1 L_at_end
    s_lshr_b32 s28, s2, 4
    s_and_b32 s29, s2, 15
    s_lshl_b32 s29, s29, 7
    v_lshrrev_b32 v1, 6, v0
    s_nop 0
    v_readfirstlane_b32 s22, v1
    v_and_b32 v2, 63, v0
    s_nop 1
    s_lshl_b32 s21, s22, 10
    s_waitcnt lgkmcnt(0)
    s_lshr_b32 s26, s28, 3
    s_lshl_b32 s26, s26, 19
    s_add_u32 s4, s32, s26
    s_addc_u32 s5, s33, 0
    s_mov_b32 s6, 0x80000
    s_mov_b32 s7, 0x00020000
    s_add_u32 s8, s34, s26
    s_addc_u32 s9, s35, 0
    s_mov_b32 s10, 0x80000
    s_mov_b32 s11, 0x00020000
    s_add_u32 s12, s36, 0x400000
    s_addc_u32 s13, s37, 0
    s_mov_b32 s14, 0x1000000
    s_mov_b32 s15, 0x00020000
    s_add_u32 s16, s36, 0x2400000
    s_addc_u32 s17, s37, 0
    s_mov_b32 s18, 0x1000000
    s_mov_b32 s19, 0x00020000
    s_mov_b32 s40, s48
    s_mov_b32 s41, s49
    s_mov_b32 s42, 0x800000
    s_mov_b32 s43, 0x00020000
    s_mov_b32 s44, s50
    s_mov_b32 s45, s51
    s_mov_b32 s46, 0x700000
    s_mov_b32 s47, 0x00020000
    s_lshl_b32 s52, s2, 14
    s_mov_b32 s20, 0x60000
    s_mov_b32 s23, 0x3e0293ee
    s_mov_b32 s24, 0xbe0293ee
    s_mov_b32 s31, 0x427af233
    s_movk_i32 s25, 3
    v_and_b32 v3, 31, v2
    s_lshl_b32 s26, s22, 5
    s_add_u32 s26, s26, s29
    v_add_u32 v3, s26, v3
    v_lshlrev_b32 v3, 13, v3
    v_lshrrev_b32 v4, 5, v2
    v_lshlrev_b32 v4, 4, v4
    s_lshl_b32 s26, s28, 8
    v_add3_u32 v248, v3, v4, s26
    buffer_load_dwordx4 v[8:11], v248, s[12:15], 0 offen offset:0
    buffer_load_dwordx4 v[12:15], v248, s[12:15], 0 offen offset:32
    buffer_load_dwordx4 v[16:19], v248, s[12:15], 0 offen offset:64
    buffer_load_dwordx4 v[20:23], v248, s[12:15], 0 offen offset:96
    buffer_load_dwordx4 v[24:27], v248, s[12:15], 0 offen offset:128
    buffer_load_dwordx4 v[28:31], v248, s[12:15], 0 offen offset:160
    buffer_load_dwordx4 v[32:35], v248, s[12:15], 0 offen offset:192
    buffer_load_dwordx4 v[36:39], v248, s[12:15], 0 offen offset:224
    v_lshrrev_b32 v3, 4, v2
    s_lshl_b32 s26, s22, 2
    v_add_u32 v3, s26, v3
    v_and_b32 v4, 15, v2
    v_xor_b32 v5, v4, v3
    v_lshlrev_b32 v5, 4, v5
    v_lshl_add_u32 v228, v3, 8, v5
    v_bfe_u32 v5, v2, 4, 2
    v_lshlrev_b32 v5, 2, v5
    v_xor_b32 v5, v4, v5
    v_lshlrev_b32 v5, 4, v5
    v_lshl_add_u32 v232, v3, 8, v5
    v_add_u32 v229, 0x1000, v228
    v_add_u32 v233, 0x1000, v232
    v_add_u32 v230, 0x1000, v229
    v_add_u32 v234, 0x1000, v233
    v_add_u32 v231, 0x1000, v230
    v_add_u32 v235, 0x1000, v234
    v_and_b32 v3, 31, v2
    v_lshlrev_b32 v3, 8, v3
    v_lshrrev_b32 v4, 5, v2
    v_and_b32 v5, 15, v2
    v_xor_b32 v4, v4, v5
    v_xor_b32 v5, 0, v4
    v_lshl_add_u32 v216, v5, 4, v3
    v_xor_b32 v5, 2, v4
    v_lshl_add_u32 v217, v5, 4, v3
    v_xor_b32 v5, 4, v4
    v_lshl_add_u32 v218, v5, 4, v3
    v_xor_b32 v5, 6, v4
    v_lshl_add_u32 v219, v5, 4, v3
    v_xor_b32 v5, 8, v4
    v_lshl_add_u32 v220, v5, 4, v3
    v_xor_b32 v5, 10, v4
    v_lshl_add_u32 v221, v5, 4, v3
    v_xor_b32 v5, 12, v4
    v_lshl_add_u32 v222, v5, 4, v3
    v_xor_b32 v5, 14, v4
    v_lshl_add_u32 v223, v5, 4, v3
    v_lshrrev_b32 v3, 5, v2
    v_lshlrev_b32 v3, 2, v3
    v_bfe_u32 v4, v2, 2, 2
    v_add_u32 v3, v3, v4
    v_lshlrev_b32 v3, 8, v3
    v_bfe_u32 v5, v2, 4, 1
    v_lshlrev_b32 v5, 5, v5
    v_and_b32 v6, 3, v2
    v_lshl_add_u32 v5, v6, 3, v5
    v_add_u32 v3, v3, v5
    v_add_u32 v3, 0x8000, v3
    v_xor_b32 v6, 0, v4
    v_lshl_add_u32 v224, v6, 6, v3
    v_xor_b32 v6, 1, v4
    v_lshl_add_u32 v225, v6, 6, v3
    v_xor_b32 v6, 2, v4
    v_lshl_add_u32 v226, v6, 6, v3
    v_xor_b32 v6, 3, v4
    v_lshl_add_u32 v227, v6, 6, v3
    v_lshlrev_b32 v7, 4, v2
    s_lshl_b32 s53, s22, 12
    s_add_u32 s52, s52, s53
    s_mov_b32 s53, s52
    v_mov_b32 v236, 0xff7fffff
    v_mov_b32 v237, 0
    v_mov_b32 v104, 0
    v_mov_b32 v105, 0
    v_mov_b32 v106, 0
    v_mov_b32 v107, 0
    v_mov_b32 v108, 0
    v_mov_b32 v109, 0
    v_mov_b32 v110, 0
    v_mov_b32 v111, 0
    v_mov_b32 v112, 0
    v_mov_b32 v113, 0
    v_mov_b32 v114, 0
    v_mov_b32 v115, 0
    v_mov_b32 v116, 0
    v_mov_b32 v117, 0
    v_mov_b32 v118, 0
    v_mov_b32 v119, 0
    v_mov_b32 v120, 0
    v_mov_b32 v121, 0
    v_mov_b32 v122, 0
    v_mov_b32 v123, 0
    v_mov_b32 v124, 0
    v_mov_b32 v125, 0
    v_mov_b32 v126, 0
    v_mov_b32 v127, 0
    v_mov_b32 v128, 0
    v_mov_b32 v129, 0
    v_mov_b32 v130, 0
    v_mov_b32 v131, 0
    v_mov_b32 v132, 0
    v_mov_b32 v133, 0
    v_mov_b32 v134, 0
    v_mov_b32 v135, 0
    v_mov_b32 v136, 0
    v_mov_b32 v137, 0
    v_mov_b32 v138, 0
    v_mov_b32 v139, 0
    v_mov_b32 v140, 0
    v_mov_b32 v141, 0
    v_mov_b32 v142, 0
    v_mov_b32 v143, 0
    v_mov_b32 v144, 0
    v_mov_b32 v145, 0
    v_mov_b32 v146, 0
    v_mov_b32 v147, 0
    v_mov_b32 v148, 0
    v_mov_b32 v149, 0
    v_mov_b32 v150, 0
    v_mov_b32 v151, 0
    v_mov_b32 v152, 0
    v_mov_b32 v153, 0
    v_mov_b32 v154, 0
    v_mov_b32 v155, 0
    v_mov_b32 v156, 0
    v_mov_b32 v157, 0
    v_mov_b32 v158, 0
    v_mov_b32 v159, 0
    v_mov_b32 v160, 0
    v_mov_b32 v161, 0
    v_mov_b32 v162, 0
    v_mov_b32 v163, 0
    v_mov_b32 v164, 0
    v_mov_b32 v165, 0
    v_mov_b32 v166, 0
    v_mov_b32 v167, 0
    s_mov_b32 s30, s20
    s_add_u32 m0, s21, 0x0
    s_nop 0
    buffer_load_dwordx4 v228, s[4:7], s30 offen lds
    s_add_u32 m0, s21, 0x1000
    s_nop 0
    buffer_load_dwordx4 v229, s[4:7], s30 offen lds
    s_add_u32 m0, s21, 0x2000
    s_nop 0
    buffer_load_dwordx4 v230, s[4:7], s30 offen lds
    s_add_u32 m0, s21, 0x3000
    s_nop 0
    buffer_load_dwordx4 v231, s[4:7], s30 offen lds
    s_add_u32 s30, s30, 0x4000
    s_mov_b32 m0, 0x10000
    s_nop 0
    buffer_load_dwordx4 v7, s[44:47], s53 offen lds
    s_add_u32 s53, s53, 0x400
    s_add_u32 m0, s21, 0x4000
    s_nop 0
    buffer_load_dwordx4 v228, s[4:7], s30 offen lds
    s_add_u32 m0, s21, 0x5000
    s_nop 0
    buffer_load_dwordx4 v229, s[4:7], s30 offen lds
    s_add_u32 m0, s21, 0x6000
    s_nop 0
    buffer_load_dwordx4 v230, s[4:7], s30 offen lds
    s_add_u32 m0, s21, 0x7000
    s_nop 0
    buffer_load_dwordx4 v231, s[4:7], s30 offen lds
    s_add_u32 s30, s30, 0x4000
    s_add_u32 m0, s21, 0x8000
    s_nop 0
    buffer_load_dwordx4 v232, s[8:11], s20 offen lds
    s_add_u32 m0, s21, 0x9000
    s_nop 0
    buffer_load_dwordx4 v233, s[8:11], s20 offen lds
    s_add_u32 m0, s21, 0xa000
    s_nop 0
    buffer_load_dwordx4 v234, s[8:11], s20 offen lds
    s_add_u32 m0, s21, 0xb000
    s_nop 0
    buffer_load_dwordx4 v235, s[8:11], s20 offen lds
    s_add_u32 s20, s20, 0x4000
    s_mov_b32 m0, 0x10000
    s_nop 0
    buffer_load_dwordx4 v7, s[44:47], s53 offen lds
    s_add_u32 s53, s53, 0x400
    s_waitcnt vmcnt(10)
    s_barrier
    ds_read_b128 v[184:187], v216 offset:0
    ds_read_b128 v[188:191], v217 offset:0
    ds_read_b128 v[192:195], v218 offset:0
    ds_read_b128 v[196:199], v219 offset:0
    ds_read_b128 v[200:203], v220 offset:0
    ds_read_b128 v[204:207], v221 offset:0
    ds_read_b128 v[208:211], v222 offset:0
    ds_read_b128 v[212:215], v223 offset:0
    s_waitcnt lgkmcnt(7)
    v_mfma_f32_32x32x16_bf16 v[40:55], v[184:187], v[8:11], 0
    ds_read_b128 v[184:187], v216 offset:8192
    s_waitcnt lgkmcnt(7)
    v_mfma_f32_32x32x16_bf16 v[40:55], v[188:191], v[12:15], v[40:55]
    ds_read_b128 v[188:191], v217 offset:8192
    s_waitcnt lgkmcnt(7)
    v_mfma_f32_32x32x16_bf16 v[40:55], v[192:195], v[16:19], v[40:55]
    ds_read_b128 v[192:195], v218 offset:8192
    s_waitcnt lgkmcnt(7)
    v_mfma_f32_32x32x16_bf16 v[40:55], v[196:199], v[20:23], v[40:55]
    ds_read_b128 v[196:199], v219 offset:8192
    s_waitcnt lgkmcnt(7)
    v_mfma_f32_32x32x16_bf16 v[40:55], v[200:203], v[24:27], v[40:55]
    ds_read_b128 v[200:203], v220 offset:8192
    s_waitcnt lgkmcnt(7)
    v_mfma_f32_32x32x16_bf16 v[40:55], v[204:207], v[28:31], v[40:55]
    ds_read_b128 v[204:207], v221 offset:8192
    s_waitcnt lgkmcnt(7)
    v_mfma_f32_32x32x16_bf16 v[40:55], v[208:211], v[32:35], v[40:55]
    ds_read_b128 v[208:211], v222 offset:8192
    s_waitcnt lgkmcnt(7)
    v_mfma_f32_32x32x16_bf16 v[40:55], v[212:215], v[36:39], v[40:55]
    ds_read_b128 v[212:215], v223 offset:8192
    s_waitcnt lgkmcnt(7)
    v_mfma_f32_32x32x16_bf16 v[56:71], v[184:187], v[8:11], 0
    s_waitcnt lgkmcnt(6)
    v_mfma_f32_32x32x16_bf16 v[56:71], v[188:191], v[12:15], v[56:71]
    s_waitcnt lgkmcnt(5)
    v_mfma_f32_32x32x16_bf16 v[56:71], v[192:195], v[16:19], v[56:71]
    s_waitcnt lgkmcnt(4)
    v_mfma_f32_32x32x16_bf16 v[56:71], v[196:199], v[20:23], v[56:71]
    s_waitcnt lgkmcnt(3)
    v_mfma_f32_32x32x16_bf16 v[56:71], v[200:203], v[24:27], v[56:71]
    s_waitcnt lgkmcnt(2)
    v_mfma_f32_32x32x16_bf16 v[56:71], v[204:207], v[28:31], v[56:71]
    s_waitcnt lgkmcnt(1)
    v_mfma_f32_32x32x16_bf16 v[56:71], v[208:211], v[32:35], v[56:71]
    s_waitcnt lgkmcnt(0)
    v_mfma_f32_32x32x16_bf16 v[56:71], v[212:215], v[36:39], v[56:71]
L_at_loop:
    s_waitcnt vmcnt(1)
    s_barrier
    s_add_u32 m0, s21, 0x0
    s_nop 0
    buffer_load_dwordx4 v228, s[4:7], s30 offen lds
    s_add_u32 m0, s21, 0x1000
    s_nop 0
    buffer_load_dwordx4 v229, s[4:7], s30 offen lds
    s_add_u32 m0, s21, 0x2000
    s_nop 0
    buffer_load_dwordx4 v230, s[4:7], s30 offen lds
    s_add_u32 m0, s21, 0x3000
    s_nop 0
    buffer_load_dwordx4 v231, s[4:7], s30 offen lds
    s_add_u32 s30, s30, 0x4000
    s_add_u32 m0, s21, 0xc000
    s_nop 0
    buffer_load_dwordx4 v232, s[8:11], s20 offen lds
    s_add_u32 m0, s21, 0xd000
    s_nop 0
    buffer_load_dwordx4 v233, s[8:11], s20 offen lds
    s_add_u32 m0, s21, 0xe000
    s_nop 0
    buffer_load_dwordx4 v234, s[8:11], s20 offen lds
    s_add_u32 m0, s21, 0xf000
    s_nop 0
    buffer_load_dwordx4 v235, s[8:11], s20 offen lds
    s_add_u32 s20, s20, 0x4000
    s_mov_b32 m0, 0x10000
    s_nop 0
    buffer_load_dwordx4 v7, s[40:43], s52 offen lds
    s_add_u32 s52, s52, 0x400
    ds_read_b128 v[184:187], v216 offset:16384
    ds_read_b128 v[188:191], v217 offset:16384
    ds_read_b128 v[192:195], v218 offset:16384
    ds_read_b128 v[196:199], v219 offset:16384
    ds_read_b128 v[200:203], v220 offset:16384
    ds_read_b128 v[204:207], v221 offset:16384
    ds_read_b128 v[208:211], v222 offset:16384
    ds_read_b128 v[212:215], v223 offset:16384
    s_waitcnt lgkmcnt(7)
    v_mfma_f32_32x32x16_bf16 v[72:87], v[184:187], v[8:11], 0
    v_max3_f32 v240, v40, v41, v42
    v_max3_f32 v240, v240, v43, v44
    v_max3_f32 v240, v240, v45, v46
    v_max_f32 v240, v240, v47
    v_max3_f32 v241, v48, v49, v50
    v_max3_f32 v241, v241, v51, v52
    v_max3_f32 v241, v241, v53, v54
    v_max_f32 v241, v241, v55
    v_max3_f32 v242, v56, v57, v58
    ds_read_b128 v[184:187], v216 offset:24576
    s_waitcnt lgkmcnt(7)
    v_mfma_f32_32x32x16_bf16 v[72:87], v[188:191], v[12:15], v[72:87]
    v_max3_f32 v242, v242, v59, v60
    v_max3_f32 v242, v242, v61, v62
    v_max_f32 v242, v242, v63
    v_max3_f32 v243, v64, v65, v66
    v_max3_f32 v243, v243, v67, v68
    v_max3_f32 v243, v243, v69, v70
    v_max_f32 v243, v243, v71
    v_max3_f32 v240, v240, v241, v242
    v_max_f32 v240, v240, v243
    ds_read_b128 v[188:191], v217 offset:24576
    s_waitcnt lgkmcnt(7)
    v_mfma_f32_32x32x16_bf16 v[72:87], v[192:195], v[16:19], v[72:87]
    v_mov_b32 v241, v240
    s_nop 1
    v_permlane32_swap_b32 v240, v241
    v_max_f32 v240, v240, v241
    v_sub_f32 v241, v240, v236
    v_cmp_lt_f32 vcc, s31, v241
    s_nop 4
    s_cbranch_vccz L_at_nors_5
    v_max_f32 v241, v240, v236
    v_sub_f32 v239, v236, v241
    v_mul_f32 v239, s23, v239
    v_exp_f32 v239, v239
    v_mov_b32 v236, v241
    v_mul_f32 v237, v237, v239
    v_mul_f32 v104, v104, v239
    v_mul_f32 v105, v105, v239
    v_mul_f32 v106, v106, v239
    v_mul_f32 v107, v107, v239
    v_mul_f32 v108, v108, v239
    v_mul_f32 v109, v109, v239
    v_mul_f32 v110, v110, v239
    v_mul_f32 v111, v111, v239
    v_mul_f32 v112, v112, v239
    v_mul_f32 v113, v113, v239
    v_mul_f32 v114, v114, v239
    v_mul_f32 v115, v115, v239
    v_mul_f32 v116, v116, v239
    v_mul_f32 v117, v117, v239
    v_mul_f32 v118, v118, v239
    v_mul_f32 v119, v119, v239
    v_mul_f32 v120, v120, v239
    v_mul_f32 v121, v121, v239
    v_mul_f32 v122, v122, v239
    v_mul_f32 v123, v123, v239
    v_mul_f32 v124, v124, v239
    v_mul_f32 v125, v125, v239
    v_mul_f32 v126, v126, v239
    v_mul_f32 v127, v127, v239
    v_mul_f32 v128, v128, v239
    v_mul_f32 v129, v129, v239
    v_mul_f32 v130, v130, v239
    v_mul_f32 v131, v131, v239
    v_mul_f32 v132, v132, v239
    v_mul_f32 v133, v133, v239
    v_mul_f32 v134, v134, v239
    v_mul_f32 v135, v135, v239
    v_mul_f32 v136, v136, v239
    v_mul_f32 v137, v137, v239
    v_mul_f32 v138, v138, v239
    v_mul_f32 v139, v139, v239
    v_mul_f32 v140, v140, v239
    v_mul_f32 v141, v141, v239
    v_mul_f32 v142, v142, v239
    v_mul_f32 v143, v143, v239
    v_mul_f32 v144, v144, v239
    v_mul_f32 v145, v145, v239
    v_mul_f32 v146, v146, v239
    v_mul_f32 v147, v147, v239
    v_mul_f32 v148, v148, v239
    v_mul_f32 v149, v149, v239
    v_mul_f32 v150, v150, v239
    v_mul_f32 v151, v151, v239
    v_mul_f32 v152, v152, v239
    v_mul_f32 v153, v153, v239
    v_mul_f32 v154, v154, v239
    v_mul_f32 v155, v155, v239
    v_mul_f32 v156, v156, v239
    v_mul_f32 v157, v157, v239
    v_mul_f32 v158, v158, v239
    v_mul_f32 v159, v159, v239
    v_mul_f32 v160, v160, v239
    v_mul_f32 v161, v161, v239
    v_mul_f32 v162, v162, v239
    v_mul_f32 v163, v163, v239
    v_mul_f32 v164, v164, v239
    v_mul_f32 v165, v165, v239
    v_mul_f32 v166, v166, v239
    v_mul_f32 v167, v167, v239
L_at_nors_5:
    v_mul_f32 v238, s24, v236
    v_fma_f32 v40, v40, s23, v238
    v_fma_f32 v41, v41, s23, v238
    v_fma_f32 v42, v42, s23, v238
    ds_read_b128 v[192:195], v218 offset:24576
    s_waitcnt lgkmcnt(7)
    v_mfma_f32_32x32x16_bf16 v[72:87], v[196:199], v[20:23], v[72:87]
    v_fma_f32 v43, v43, s23, v238
    v_fma_f32 v44, v44, s23, v238
    v_fma_f32 v45, v45, s23, v238
    v_fma_f32 v46, v46, s23, v238
    v_fma_f32 v47, v47, s23, v238
    v_fma_f32 v48, v48, s23, v238
    v_fma_f32 v49, v49, s23, v238
    v_fma_f32 v50, v50, s23, v238
    v_fma_f32 v51, v51, s23, v238
    ds_read_b128 v[196:199], v219 offset:24576
    s_waitcnt lgkmcnt(7)
    v_mfma_f32_32x32x16_bf16 v[72:87], v[200:203], v[24:27], v[72:87]
    v_fma_f32 v52, v52, s23, v238
    v_fma_f32 v53, v53, s23, v238
    v_fma_f32 v54, v54, s23, v238
    v_fma_f32 v55, v55, s23, v238
    v_fma_f32 v56, v56, s23, v238
    v_fma_f32 v57, v57, s23, v238
    v_fma_f32 v58, v58, s23, v238
    v_fma_f32 v59, v59, s23, v238
    v_fma_f32 v60, v60, s23, v238
    ds_read_b128 v[200:203], v220 offset:24576
    s_waitcnt lgkmcnt(7)
    v_mfma_f32_32x32x16_bf16 v[72:87], v[204:207], v[28:31], v[72:87]
    v_fma_f32 v61, v61, s23, v238
    v_fma_f32 v62, v62, s23, v238
    v_fma_f32 v63, v63, s23, v238
    v_fma_f32 v64, v64, s23, v238
    v_fma_f32 v65, v65, s23, v238
    v_fma_f32 v66, v66, s23, v238
    v_fma_f32 v67, v67, s23, v238
    v_fma_f32 v68, v68, s23, v238
    v_fma_f32 v69, v69, s23, v238
    ds_read_b128 v[204:207], v221 offset:24576
    s_waitcnt lgkmcnt(7)
    v_mfma_f32_32x32x16_bf16 v[72:87], v[208:211], v[32:35], v[72:87]
    v_fma_f32 v70, v70, s23, v238
    v_fma_f32 v71, v71, s23, v238
    v_exp_f32 v40, v40
    v_exp_f32 v41, v41
    v_exp_f32 v42, v42
    v_exp_f32 v43, v43
    v_exp_f32 v44, v44
    v_exp_f32 v45, v45
    v_exp_f32 v46, v46
    ds_read_b128 v[208:211], v222 offset:24576
    s_waitcnt lgkmcnt(7)
    v_mfma_f32_32x32x16_bf16 v[72:87], v[212:215], v[36:39], v[72:87]
    v_exp_f32 v47, v47
    v_exp_f32 v48, v48
    v_exp_f32 v49, v49
    v_exp_f32 v50, v50
    v_exp_f32 v51, v51
    v_exp_f32 v52, v52
    v_exp_f32 v53, v53
    v_exp_f32 v54, v54
    v_exp_f32 v55, v55
    ds_read_b128 v[212:215], v223 offset:24576
    s_waitcnt lgkmcnt(7)
    v_mfma_f32_32x32x16_bf16 v[88:103], v[184:187], v[8:11], 0
    v_exp_f32 v56, v56
    v_exp_f32 v57, v57
    v_exp_f32 v58, v58
    v_exp_f32 v59, v59
    v_exp_f32 v60, v60
    v_exp_f32 v61, v61
    v_exp_f32 v62, v62
    v_exp_f32 v63, v63
    v_exp_f32 v64, v64
    s_waitcnt lgkmcnt(6)
    v_mfma_f32_32x32x16_bf16 v[88:103], v[188:191], v[12:15], v[88:103]
    ds_read_b64_tr_b16 v[184:185], v224 offset:0
    ds_read_b64_tr_b16 v[186:187], v224 offset:2048
    v_exp_f32 v65, v65
    v_exp_f32 v66, v66
    v_exp_f32 v67, v67
    v_exp_f32 v68, v68
    v_exp_f32 v69, v69
    v_exp_f32 v70, v70
    v_exp_f32 v71, v71
    v_add_f32 v244, v40, v41
    v_add_f32 v245, v48, v49
    s_waitcnt lgkmcnt(7)
    v_mfma_f32_32x32x16_bf16 v[88:103], v[192:195], v[16:19], v[88:103]
    ds_read_b64_tr_b16 v[188:189], v224 offset:4096
    ds_read_b64_tr_b16 v[190:191], v224 offset:6144
    v_add_f32 v246, v56, v57
    v_add_f32 v247, v64, v65
    v_add_f32 v244, v244, v42
    v_add_f32 v245, v245, v50
    v_add_f32 v246, v246, v58
    v_add_f32 v247, v247, v66
    v_add_f32 v244, v244, v43
    v_add_f32 v245, v245, v51
    v_add_f32 v246, v246, v59
    s_waitcnt lgkmcnt(8)
    v_mfma_f32_32x32x16_bf16 v[88:103], v[196:199], v[20:23], v[88:103]
    ds_read_b64_tr_b16 v[192:193], v224 offset:8192
    ds_read_b64_tr_b16 v[194:195], v224 offset:10240
    v_add_f32 v247, v247, v67
    v_add_f32 v244, v244, v44
    v_add_f32 v245, v245, v52
    v_add_f32 v246, v246, v60
    v_add_f32 v247, v247, v68
    v_add_f32 v244, v244, v45
    v_add_f32 v245, v245, v53
    v_add_f32 v246, v246, v61
    v_add_f32 v247, v247, v69
    s_waitcnt lgkmcnt(9)
    v_mfma_f32_32x32x16_bf16 v[88:103], v[200:203], v[24:27], v[88:103]
    ds_read_b64_tr_b16 v[196:197], v224 offset:12288
    ds_read_b64_tr_b16 v[198:199], v224 offset:14336
    v_add_f32 v244, v244, v46
    v_add_f32 v245, v245, v54
    v_add_f32 v246, v246, v62
    v_add_f32 v247, v247, v70
    v_add_f32 v244, v244, v47
    v_add_f32 v245, v245, v55
    v_add_f32 v246, v246, v63
    v_add_f32 v247, v247, v71
    v_add_f32 v244, v244, v245
    s_waitcnt lgkmcnt(10)
    v_mfma_f32_32x32x16_bf16 v[88:103], v[204:207], v[28:31], v[88:103]
    ds_read_b64_tr_b16 v[200:201], v225 offset:0
    ds_read_b64_tr_b16 v[202:203], v225 offset:2048
    v_add_f32 v246, v246, v247
    v_add_f32 v244, v244, v246
    v_add_f32 v237, v237, v244
    v_cvt_pk_bf16_f32 v168, v40, v41
    v_cvt_pk_bf16_f32 v169, v42, v43
    v_cvt_pk_bf16_f32 v170, v44, v45
    v_cvt_pk_bf16_f32 v171, v46, v47
    v_cvt_pk_bf16_f32 v172, v48, v49
    v_cvt_pk_bf16_f32 v173, v50, v51
    s_waitcnt lgkmcnt(11)
    v_mfma_f32_32x32x16_bf16 v[88:103], v[208:211], v[32:35], v[88:103]
    ds_read_b64_tr_b16 v[204:205], v225 offset:4096
    ds_read_b64_tr_b16 v[206:207], v225 offset:6144
    v_cvt_pk_bf16_f32 v174, v52, v53
    v_cvt_pk_bf16_f32 v175, v54, v55
    v_cvt_pk_bf16_f32 v176, v56, v57
    v_cvt_pk_bf16_f32 v177, v58, v59
    v_cvt_pk_bf16_f32 v178, v60, v61
    v_cvt_pk_bf16_f32 v179, v62, v63
    v_cvt_pk_bf16_f32 v180, v64, v65
    v_cvt_pk_bf16_f32 v181, v66, v67
    v_cvt_pk_bf16_f32 v182, v68, v69
    s_waitcnt lgkmcnt(12)
    v_mfma_f32_32x32x16_bf16 v[88:103], v[212:215], v[36:39], v[88:103]
    ds_read_b64_tr_b16 v[208:209], v225 offset:8192
    ds_read_b64_tr_b16 v[210:211], v225 offset:10240
    v_cvt_pk_bf16_f32 v183, v70, v71
    ds_read_b64_tr_b16 v[212:213], v225 offset:12288
    ds_read_b64_tr_b16 v[214:215], v225 offset:14336
    s_waitcnt lgkmcnt(14)
    v_mfma_f32_32x32x16_bf16 v[104:119], v[184:187], v[168:171], v[104:119]
    ds_read_b64_tr_b16 v[184:185], v226 offset:0
    ds_read_b64_tr_b16 v[186:187], v226 offset:2048
    s_waitcnt lgkmcnt(14)
    v_mfma_f32_32x32x16_bf16 v[104:119], v[188:191], v[172:175], v[104:119]
    ds_read_b64_tr_b16 v[188:189], v226 offset:4096
    ds_read_b64_tr_b16 v[190:191], v226 offset:6144
    s_waitcnt lgkmcnt(14)
    v_mfma_f32_32x32x16_bf16 v[104:119], v[192:195], v[176:179], v[104:119]
    ds_read_b64_tr_b16 v[192:193], v226 offset:8192
    ds_read_b64_tr_b16 v[194:195], v226 offset:10240
    s_waitcnt lgkmcnt(14)
    v_mfma_f32_32x32x16_bf16 v[104:119], v[196:199], v[180:183], v[104:119]
    ds_read_b64_tr_b16 v[196:197], v226 offset:12288
    ds_read_b64_tr_b16 v[198:199], v226 offset:14336
    s_waitcnt lgkmcnt(14)
    v_mfma_f32_32x32x16_bf16 v[120:135], v[200:203], v[168:171], v[120:135]
    ds_read_b64_tr_b16 v[200:201], v227 offset:0
    ds_read_b64_tr_b16 v[202:203], v227 offset:2048
    s_waitcnt lgkmcnt(14)
    v_mfma_f32_32x32x16_bf16 v[120:135], v[204:207], v[172:175], v[120:135]
    ds_read_b64_tr_b16 v[204:205], v227 offset:4096
    ds_read_b64_tr_b16 v[206:207], v227 offset:6144
    s_waitcnt lgkmcnt(14)
    v_mfma_f32_32x32x16_bf16 v[120:135], v[208:211], v[176:179], v[120:135]
    ds_read_b64_tr_b16 v[208:209], v227 offset:8192
    ds_read_b64_tr_b16 v[210:211], v227 offset:10240
    s_waitcnt lgkmcnt(14)
    v_mfma_f32_32x32x16_bf16 v[120:135], v[212:215], v[180:183], v[120:135]
    ds_read_b64_tr_b16 v[212:213], v227 offset:12288
    ds_read_b64_tr_b16 v[214:215], v227 offset:14336
    s_waitcnt lgkmcnt(14)
    v_mfma_f32_32x32x16_bf16 v[136:151], v[184:187], v[168:171], v[136:151]
    s_waitcnt lgkmcnt(12)
    v_mfma_f32_32x32x16_bf16 v[136:151], v[188:191], v[172:175], v[136:151]
    s_waitcnt lgkmcnt(10)
    v_mfma_f32_32x32x16_bf16 v[136:151], v[192:195], v[176:179], v[136:151]
    s_waitcnt lgkmcnt(8)
    v_mfma_f32_32x32x16_bf16 v[136:151], v[196:199], v[180:183], v[136:151]
    s_waitcnt lgkmcnt(6)
    v_mfma_f32_32x32x16_bf16 v[152:167], v[200:203], v[168:171], v[152:167]
    s_waitcnt lgkmcnt(4)
    v_mfma_f32_32x32x16_bf16 v[152:167], v[204:207], v[172:175], v[152:167]
    s_waitcnt lgkmcnt(2)
    v_mfma_f32_32x32x16_bf16 v[152:167], v[208:211], v[176:179], v[152:167]
    s_waitcnt lgkmcnt(0)
    v_mfma_f32_32x32x16_bf16 v[152:167], v[212:215], v[180:183], v[152:167]
    s_waitcnt vmcnt(1)
    s_barrier
    s_add_u32 m0, s21, 0x4000
    s_nop 0
    buffer_load_dwordx4 v228, s[4:7], s30 offen lds
    s_add_u32 m0, s21, 0x5000
    s_nop 0
    buffer_load_dwordx4 v229, s[4:7], s30 offen lds
    s_add_u32 m0, s21, 0x6000
    s_nop 0
    buffer_load_dwordx4 v230, s[4:7], s30 offen lds
    s_add_u32 m0, s21, 0x7000
    s_nop 0
    buffer_load_dwordx4 v231, s[4:7], s30 offen lds
    s_add_u32 s30, s30, 0x4000
    s_add_u32 m0, s21, 0x8000
    s_nop 0
    buffer_load_dwordx4 v232, s[8:11], s20 offen lds
    s_add_u32 m0, s21, 0x9000
    s_nop 0
    buffer_load_dwordx4 v233, s[8:11], s20 offen lds
    s_add_u32 m0, s21, 0xa000
    s_nop 0
    buffer_load_dwordx4 v234, s[8:11], s20 offen lds
    s_add_u32 m0, s21, 0xb000
    s_nop 0
    buffer_load_dwordx4 v235, s[8:11], s20 offen lds
    s_add_u32 s20, s20, 0x4000
    s_mov_b32 m0, 0x10000
    s_nop 0
    buffer_load_dwordx4 v7, s[44:47], s53 offen lds
    s_add_u32 s53, s53, 0x400
    ds_read_b128 v[184:187], v216 offset:0
    ds_read_b128 v[188:191], v217 offset:0
    ds_read_b128 v[192:195], v218 offset:0
    ds_read_b128 v[196:199], v219 offset:0
    ds_read_b128 v[200:203], v220 offset:0
    ds_read_b128 v[204:207], v221 offset:0
    ds_read_b128 v[208:211], v222 offset:0
    ds_read_b128 v[212:215], v223 offset:0
    s_waitcnt lgkmcnt(7)
    v_mfma_f32_32x32x16_bf16 v[40:55], v[184:187], v[8:11], 0
    v_max3_f32 v240, v72, v73, v74
    v_max3_f32 v240, v240, v75, v76
    v_max3_f32 v240, v240, v77, v78
    v_max_f32 v240, v240, v79
    v_max3_f32 v241, v80, v81, v82
    v_max3_f32 v241, v241, v83, v84
    v_max3_f32 v241, v241, v85, v86
    v_max_f32 v241, v241, v87
    v_max3_f32 v242, v88, v89, v90
    ds_read_b128 v[184:187], v216 offset:8192
    s_waitcnt lgkmcnt(7)
    v_mfma_f32_32x32x16_bf16 v[40:55], v[188:191], v[12:15], v[40:55]
    v_max3_f32 v242, v242, v91, v92
    v_max3_f32 v242, v242, v93, v94
    v_max_f32 v242, v242, v95
    v_max3_f32 v243, v96, v97, v98
    v_max3_f32 v243, v243, v99, v100
    v_max3_f32 v243, v243, v101, v102
    v_max_f32 v243, v243, v103
    v_max3_f32 v240, v240, v241, v242
    v_max_f32 v240, v240, v243
    ds_read_b128 v[188:191], v217 offset:8192
    s_waitcnt lgkmcnt(7)
    v_mfma_f32_32x32x16_bf16 v[40:55], v[192:195], v[16:19], v[40:55]
    v_mov_b32 v241, v240
    s_nop 1
    v_permlane32_swap_b32 v240, v241
    v_max_f32 v240, v240, v241
    v_sub_f32 v241, v240, v236
    v_cmp_lt_f32 vcc, s31, v241
    s_nop 4
    s_cbranch_vccz L_at_nors_6
    v_max_f32 v241, v240, v236
    v_sub_f32 v239, v236, v241
    v_mul_f32 v239, s23, v239
    v_exp_f32 v239, v239
    v_mov_b32 v236, v241
    v_mul_f32 v237, v237, v239
    v_mul_f32 v104, v104, v239
    v_mul_f32 v105, v105, v239
    v_mul_f32 v106, v106, v239
    v_mul_f32 v107, v107, v239
    v_mul_f32 v108, v108, v239
    v_mul_f32 v109, v109, v239
    v_mul_f32 v110, v110, v239
    v_mul_f32 v111, v111, v239
    v_mul_f32 v112, v112, v239
    v_mul_f32 v113, v113, v239
    v_mul_f32 v114, v114, v239
    v_mul_f32 v115, v115, v239
    v_mul_f32 v116, v116, v239
    v_mul_f32 v117, v117, v239
    v_mul_f32 v118, v118, v239
    v_mul_f32 v119, v119, v239
    v_mul_f32 v120, v120, v239
    v_mul_f32 v121, v121, v239
    v_mul_f32 v122, v122, v239
    v_mul_f32 v123, v123, v239
    v_mul_f32 v124, v124, v239
    v_mul_f32 v125, v125, v239
    v_mul_f32 v126, v126, v239
    v_mul_f32 v127, v127, v239
    v_mul_f32 v128, v128, v239
    v_mul_f32 v129, v129, v239
    v_mul_f32 v130, v130, v239
    v_mul_f32 v131, v131, v239
    v_mul_f32 v132, v132, v239
    v_mul_f32 v133, v133, v239
    v_mul_f32 v134, v134, v239
    v_mul_f32 v135, v135, v239
    v_mul_f32 v136, v136, v239
    v_mul_f32 v137, v137, v239
    v_mul_f32 v138, v138, v239
    v_mul_f32 v139, v139, v239
    v_mul_f32 v140, v140, v239
    v_mul_f32 v141, v141, v239
    v_mul_f32 v142, v142, v239
    v_mul_f32 v143, v143, v239
    v_mul_f32 v144, v144, v239
    v_mul_f32 v145, v145, v239
    v_mul_f32 v146, v146, v239
    v_mul_f32 v147, v147, v239
    v_mul_f32 v148, v148, v239
    v_mul_f32 v149, v149, v239
    v_mul_f32 v150, v150, v239
    v_mul_f32 v151, v151, v239
    v_mul_f32 v152, v152, v239
    v_mul_f32 v153, v153, v239
    v_mul_f32 v154, v154, v239
    v_mul_f32 v155, v155, v239
    v_mul_f32 v156, v156, v239
    v_mul_f32 v157, v157, v239
    v_mul_f32 v158, v158, v239
    v_mul_f32 v159, v159, v239
    v_mul_f32 v160, v160, v239
    v_mul_f32 v161, v161, v239
    v_mul_f32 v162, v162, v239
    v_mul_f32 v163, v163, v239
    v_mul_f32 v164, v164, v239
    v_mul_f32 v165, v165, v239
    v_mul_f32 v166, v166, v239
    v_mul_f32 v167, v167, v239
L_at_nors_6:
    v_mul_f32 v238, s24, v236
    v_fma_f32 v72, v72, s23, v238
    v_fma_f32 v73, v73, s23, v238
    v_fma_f32 v74, v74, s23, v238
    ds_read_b128 v[192:195], v218 offset:8192
    s_waitcnt lgkmcnt(7)
    v_mfma_f32_32x32x16_bf16 v[40:55], v[196:199], v[20:23], v[40:55]
    v_fma_f32 v75, v75, s23, v238
    v_fma_f32 v76, v76, s23, v238
    v_fma_f32 v77, v77, s23, v238
    v_fma_f32 v78, v78, s23, v238
    v_fma_f32 v79, v79, s23, v238
    v_fma_f32 v80, v80, s23, v238
    v_fma_f32 v81, v81, s23, v238
    v_fma_f32 v82, v82, s23, v238
    v_fma_f32 v83, v83, s23, v238
    ds_read_b128 v[196:199], v219 offset:8192
    s_waitcnt lgkmcnt(7)
    v_mfma_f32_32x32x16_bf16 v[40:55], v[200:203], v[24:27], v[40:55]
    v_fma_f32 v84, v84, s23, v238
    v_fma_f32 v85, v85, s23, v238
    v_fma_f32 v86, v86, s23, v238
    v_fma_f32 v87, v87, s23, v238
    v_fma_f32 v88, v88, s23, v238
    v_fma_f32 v89, v89, s23, v238
    v_fma_f32 v90, v90, s23, v238
    v_fma_f32 v91, v91, s23, v238
    v_fma_f32 v92, v92, s23, v238
    ds_read_b128 v[200:203], v220 offset:8192
    s_waitcnt lgkmcnt(7)
    v_mfma_f32_32x32x16_bf16 v[40:55], v[204:207], v[28:31], v[40:55]
    v_fma_f32 v93, v93, s23, v238
    v_fma_f32 v94, v94, s23, v238
    v_fma_f32 v95, v95, s23, v238
    v_fma_f32 v96, v96, s23, v238
    v_fma_f32 v97, v97, s23, v238
    v_fma_f32 v98, v98, s23, v238
    v_fma_f32 v99, v99, s23, v238
    v_fma_f32 v100, v100, s23, v238
    v_fma_f32 v101, v101, s23, v238
    ds_read_b128 v[204:207], v221 offset:8192
    s_waitcnt lgkmcnt(7)
    v_mfma_f32_32x32x16_bf16 v[40:55], v[208:211], v[32:35], v[40:55]
    v_fma_f32 v102, v102, s23, v238
    v_fma_f32 v103, v103, s23, v238
    v_exp_f32 v72, v72
    v_exp_f32 v73, v73
    v_exp_f32 v74, v74
    v_exp_f32 v75, v75
    v_exp_f32 v76, v76
    v_exp_f32 v77, v77
    v_exp_f32 v78, v78
    ds_read_b128 v[208:211], v222 offset:8192
    s_waitcnt lgkmcnt(7)
    v_mfma_f32_32x32x16_bf16 v[40:55], v[212:215], v[36:39], v[40:55]
    v_exp_f32 v79, v79
    v_exp_f32 v80, v80
    v_exp_f32 v81, v81
    v_exp_f32 v82, v82
    v_exp_f32 v83, v83
    v_exp_f32 v84, v84
    v_exp_f32 v85, v85
    v_exp_f32 v86, v86
    v_exp_f32 v87, v87
    ds_read_b128 v[212:215], v223 offset:8192
    s_waitcnt lgkmcnt(7)
    v_mfma_f32_32x32x16_bf16 v[56:71], v[184:187], v[8:11], 0
    v_exp_f32 v88, v88
    v_exp_f32 v89, v89
    v_exp_f32 v90, v90
    v_exp_f32 v91, v91
    v_exp_f32 v92, v92
    v_exp_f32 v93, v93
    v_exp_f32 v94, v94
    v_exp_f32 v95, v95
    v_exp_f32 v96, v96
    s_waitcnt lgkmcnt(6)
    v_mfma_f32_32x32x16_bf16 v[56:71], v[188:191], v[12:15], v[56:71]
    ds_read_b64_tr_b16 v[184:185], v224 offset:16384
    ds_read_b64_tr_b16 v[186:187], v224 offset:18432
    v_exp_f32 v97, v97
    v_exp_f32 v98, v98
    v_exp_f32 v99, v99
    v_exp_f32 v100, v100
    v_exp_f32 v101, v101
    v_exp_f32 v102, v102
    v_exp_f32 v103, v103
    v_add_f32 v244, v72, v73
    v_add_f32 v245, v80, v81
    s_waitcnt lgkmcnt(7)
    v_mfma_f32_32x32x16_bf16 v[56:71], v[192:195], v[16:19], v[56:71]
    ds_read_b64_tr_b16 v[188:189], v224 offset:20480
    ds_read_b64_tr_b16 v[190:191], v224 offset:22528
    v_add_f32 v246, v88, v89
    v_add_f32 v247, v96, v97
    v_add_f32 v244, v244, v74
    v_add_f32 v245, v245, v82
    v_add_f32 v246, v246, v90
    v_add_f32 v247, v247, v98
    v_add_f32 v244, v244, v75
    v_add_f32 v245, v245, v83
    v_add_f32 v246, v246, v91
    s_waitcnt lgkmcnt(8)
    v_mfma_f32_32x32x16_bf16 v[56:71], v[196:199], v[20:23], v[56:71]
    ds_read_b64_tr_b16 v[192:193], v224 offset:24576
    ds_read_b64_tr_b16 v[194:195], v224 offset:26624
    v_add_f32 v247, v247, v99
    v_add_f32 v244, v244, v76
    v_add_f32 v245, v245, v84
    v_add_f32 v246, v246, v92
    v_add_f32 v247, v247, v100
    v_add_f32 v244, v244, v77
    v_add_f32 v245, v245, v85
    v_add_f32 v246, v246, v93
    v_add_f32 v247, v247, v101
    s_waitcnt lgkmcnt(9)
    v_mfma_f32_32x32x16_bf16 v[56:71], v[200:203], v[24:27], v[56:71]
    ds_read_b64_tr_b16 v[196:197], v224 offset:28672
    ds_read_b64_tr_b16 v[198:199], v224 offset:30720
    v_add_f32 v244, v244, v78
    v_add_f32 v245, v245, v86
    v_add_f32 v246, v246, v94
    v_add_f32 v247, v247, v102
    v_add_f32 v244, v244, v79
    v_add_f32 v245, v245, v87
    v_add_f32 v246, v246, v95
    v_add_f32 v247, v247, v103
    v_add_f32 v244, v244, v245
    s_waitcnt lgkmcnt(10)
    v_mfma_f32_32x32x16_bf16 v[56:71], v[204:207], v[28:31], v[56:71]
    ds_read_b64_tr_b16 v[200:201], v225 offset:16384
    ds_read_b64_tr_b16 v[202:203], v225 offset:18432
    v_add_f32 v246, v246, v247
    v_add_f32 v244, v244, v246
    v_add_f32 v237, v237, v244
    v_cvt_pk_bf16_f32 v168, v72, v73
    v_cvt_pk_bf16_f32 v169, v74, v75
    v_cvt_pk_bf16_f32 v170, v76, v77
    v_cvt_pk_bf16_f32 v171, v78, v79
    v_cvt_pk_bf16_f32 v172, v80, v81
    v_cvt_pk_bf16_f32 v173, v82, v83
    s_waitcnt lgkmcnt(11)
    v_mfma_f32_32x32x16_bf16 v[56:71], v[208:211], v[32:35], v[56:71]
    ds_read_b64_tr_b16 v[204:205], v225 offset:20480
    ds_read_b64_tr_b16 v[206:207], v225 offset:22528
    v_cvt_pk_bf16_f32 v174, v84, v85
    v_cvt_pk_bf16_f32 v175, v86, v87
    v_cvt_pk_bf16_f32 v176, v88, v89
    v_cvt_pk_bf16_f32 v177, v90, v91
    v_cvt_pk_bf16_f32 v178, v92, v93
    v_cvt_pk_bf16_f32 v179, v94, v95
    v_cvt_pk_bf16_f32 v180, v96, v97
    v_cvt_pk_bf16_f32 v181, v98, v99
    v_cvt_pk_bf16_f32 v182, v100, v101
    s_waitcnt lgkmcnt(12)
    v_mfma_f32_32x32x16_bf16 v[56:71], v[212:215], v[36:39], v[56:71]
    ds_read_b64_tr_b16 v[208:209], v225 offset:24576
    ds_read_b64_tr_b16 v[210:211], v225 offset:26624
    v_cvt_pk_bf16_f32 v183, v102, v103
    ds_read_b64_tr_b16 v[212:213], v225 offset:28672
    ds_read_b64_tr_b16 v[214:215], v225 offset:30720
    s_waitcnt lgkmcnt(14)
    v_mfma_f32_32x32x16_bf16 v[104:119], v[184:187], v[168:171], v[104:119]
    ds_read_b64_tr_b16 v[184:185], v226 offset:16384
    ds_read_b64_tr_b16 v[186:187], v226 offset:18432
    s_waitcnt lgkmcnt(14)
    v_mfma_f32_32x32x16_bf16 v[104:119], v[188:191], v[172:175], v[104:119]
    ds_read_b64_tr_b16 v[188:189], v226 offset:20480
    ds_read_b64_tr_b16 v[190:191], v226 offset:22528
    s_waitcnt lgkmcnt(14)
    v_mfma_f32_32x32x16_bf16 v[104:119], v[192:195], v[176:179], v[104:119]
    ds_read_b64_tr_b16 v[192:193], v226 offset:24576
    ds_read_b64_tr_b16 v[194:195], v226 offset:26624
    s_waitcnt lgkmcnt(14)
    v_mfma_f32_32x32x16_bf16 v[104:119], v[196:199], v[180:183], v[104:119]
    ds_read_b64_tr_b16 v[196:197], v226 offset:28672
    ds_read_b64_tr_b16 v[198:199], v226 offset:30720
    s_waitcnt lgkmcnt(14)
    v_mfma_f32_32x32x16_bf16 v[120:135], v[200:203], v[168:171], v[120:135]
    ds_read_b64_tr_b16 v[200:201], v227 offset:16384
    ds_read_b64_tr_b16 v[202:203], v227 offset:18432
    s_waitcnt lgkmcnt(14)
    v_mfma_f32_32x32x16_bf16 v[120:135], v[204:207], v[172:175], v[120:135]
    ds_read_b64_tr_b16 v[204:205], v227 offset:20480
    ds_read_b64_tr_b16 v[206:207], v227 offset:22528
    s_waitcnt lgkmcnt(14)
    v_mfma_f32_32x32x16_bf16 v[120:135], v[208:211], v[176:179], v[120:135]
    ds_read_b64_tr_b16 v[208:209], v227 offset:24576
    ds_read_b64_tr_b16 v[210:211], v227 offset:26624
    s_waitcnt lgkmcnt(14)
    v_mfma_f32_32x32x16_bf16 v[120:135], v[212:215], v[180:183], v[120:135]
    ds_read_b64_tr_b16 v[212:213], v227 offset:28672
    ds_read_b64_tr_b16 v[214:215], v227 offset:30720
    s_waitcnt lgkmcnt(14)
    v_mfma_f32_32x32x16_bf16 v[136:151], v[184:187], v[168:171], v[136:151]
    s_waitcnt lgkmcnt(12)
    v_mfma_f32_32x32x16_bf16 v[136:151], v[188:191], v[172:175], v[136:151]
    s_waitcnt lgkmcnt(10)
    v_mfma_f32_32x32x16_bf16 v[136:151], v[192:195], v[176:179], v[136:151]
    s_waitcnt lgkmcnt(8)
    v_mfma_f32_32x32x16_bf16 v[136:151], v[196:199], v[180:183], v[136:151]
    s_waitcnt lgkmcnt(6)
    v_mfma_f32_32x32x16_bf16 v[152:167], v[200:203], v[168:171], v[152:167]
    s_waitcnt lgkmcnt(4)
    v_mfma_f32_32x32x16_bf16 v[152:167], v[204:207], v[172:175], v[152:167]
    s_waitcnt lgkmcnt(2)
    v_mfma_f32_32x32x16_bf16 v[152:167], v[208:211], v[176:179], v[152:167]
    s_waitcnt lgkmcnt(0)
    v_mfma_f32_32x32x16_bf16 v[152:167], v[212:215], v[180:183], v[152:167]
    s_sub_u32 s25, s25, 1
    s_cmp_lg_u32 s25, 0
    s_cbranch_scc1 L_at_loop
    s_waitcnt vmcnt(1)
    s_barrier
    s_add_u32 m0, s21, 0x0
    s_nop 0
    buffer_load_dwordx4 v228, s[4:7], s30 offen lds
    s_add_u32 m0, s21, 0x1000
    s_nop 0
    buffer_load_dwordx4 v229, s[4:7], s30 offen lds
    s_add_u32 m0, s21, 0x2000
    s_nop 0
    buffer_load_dwordx4 v230, s[4:7], s30 offen lds
    s_add_u32 m0, s21, 0x3000
    s_nop 0
    buffer_load_dwordx4 v231, s[4:7], s30 offen lds
    s_add_u32 s30, s30, 0x4000
    s_add_u32 m0, s21, 0xc000
    s_nop 0
    buffer_load_dwordx4 v232, s[8:11], s20 offen lds
    s_add_u32 m0, s21, 0xd000
    s_nop 0
    buffer_load_dwordx4 v233, s[8:11], s20 offen lds
    s_add_u32 m0, s21, 0xe000
    s_nop 0
    buffer_load_dwordx4 v234, s[8:11], s20 offen lds
    s_add_u32 m0, s21, 0xf000
    s_nop 0
    buffer_load_dwordx4 v235, s[8:11], s20 offen lds
    s_add_u32 s20, s20, 0x4000
    s_mov_b32 m0, 0x10000
    s_nop 0
    buffer_load_dwordx4 v7, s[40:43], s52 offen lds
    s_add_u32 s52, s52, 0x400
    ds_read_b128 v[184:187], v216 offset:16384
    ds_read_b128 v[188:191], v217 offset:16384
    ds_read_b128 v[192:195], v218 offset:16384
    ds_read_b128 v[196:199], v219 offset:16384
    ds_read_b128 v[200:203], v220 offset:16384
    ds_read_b128 v[204:207], v221 offset:16384
    ds_read_b128 v[208:211], v222 offset:16384
    ds_read_b128 v[212:215], v223 offset:16384
    s_waitcnt lgkmcnt(7)
    v_mfma_f32_32x32x16_bf16 v[72:87], v[184:187], v[8:11], 0
    v_max3_f32 v240, v40, v41, v42
    v_max3_f32 v240, v240, v43, v44
    v_max3_f32 v240, v240, v45, v46
    v_max_f32 v240, v240, v47
    v_max3_f32 v241, v48, v49, v50
    v_max3_f32 v241, v241, v51, v52
    v_max3_f32 v241, v241, v53, v54
    v_max_f32 v241, v241, v55
    v_max3_f32 v242, v56, v57, v58
    ds_read_b128 v[184:187], v216 offset:24576
    s_waitcnt lgkmcnt(7)
    v_mfma_f32_32x32x16_bf16 v[72:87], v[188:191], v[12:15], v[72:87]
    v_max3_f32 v242, v242, v59, v60
    v_max3_f32 v242, v242, v61, v62
    v_max_f32 v242, v242, v63
    v_max3_f32 v243, v64, v65, v66
    v_max3_f32 v243, v243, v67, v68
    v_max3_f32 v243, v243, v69, v70
    v_max_f32 v243, v243, v71
    v_max3_f32 v240, v240, v241, v242
    v_max_f32 v240, v240, v243
    ds_read_b128 v[188:191], v217 offset:24576
    s_waitcnt lgkmcnt(7)
    v_mfma_f32_32x32x16_bf16 v[72:87], v[192:195], v[16:19], v[72:87]
    v_mov_b32 v241, v240
    s_nop 1
    v_permlane32_swap_b32 v240, v241
    v_max_f32 v240, v240, v241
    v_sub_f32 v241, v240, v236
    v_cmp_lt_f32 vcc, s31, v241
    s_nop 4
    s_cbranch_vccz L_at_nors_7
    v_max_f32 v241, v240, v236
    v_sub_f32 v239, v236, v241
    v_mul_f32 v239, s23, v239
    v_exp_f32 v239, v239
    v_mov_b32 v236, v241
    v_mul_f32 v237, v237, v239
    v_mul_f32 v104, v104, v239
    v_mul_f32 v105, v105, v239
    v_mul_f32 v106, v106, v239
    v_mul_f32 v107, v107, v239
    v_mul_f32 v108, v108, v239
    v_mul_f32 v109, v109, v239
    v_mul_f32 v110, v110, v239
    v_mul_f32 v111, v111, v239
    v_mul_f32 v112, v112, v239
    v_mul_f32 v113, v113, v239
    v_mul_f32 v114, v114, v239
    v_mul_f32 v115, v115, v239
    v_mul_f32 v116, v116, v239
    v_mul_f32 v117, v117, v239
    v_mul_f32 v118, v118, v239
    v_mul_f32 v119, v119, v239
    v_mul_f32 v120, v120, v239
    v_mul_f32 v121, v121, v239
    v_mul_f32 v122, v122, v239
    v_mul_f32 v123, v123, v239
    v_mul_f32 v124, v124, v239
    v_mul_f32 v125, v125, v239
    v_mul_f32 v126, v126, v239
    v_mul_f32 v127, v127, v239
    v_mul_f32 v128, v128, v239
    v_mul_f32 v129, v129, v239
    v_mul_f32 v130, v130, v239
    v_mul_f32 v131, v131, v239
    v_mul_f32 v132, v132, v239
    v_mul_f32 v133, v133, v239
    v_mul_f32 v134, v134, v239
    v_mul_f32 v135, v135, v239
    v_mul_f32 v136, v136, v239
    v_mul_f32 v137, v137, v239
    v_mul_f32 v138, v138, v239
    v_mul_f32 v139, v139, v239
    v_mul_f32 v140, v140, v239
    v_mul_f32 v141, v141, v239
    v_mul_f32 v142, v142, v239
    v_mul_f32 v143, v143, v239
    v_mul_f32 v144, v144, v239
    v_mul_f32 v145, v145, v239
    v_mul_f32 v146, v146, v239
    v_mul_f32 v147, v147, v239
    v_mul_f32 v148, v148, v239
    v_mul_f32 v149, v149, v239
    v_mul_f32 v150, v150, v239
    v_mul_f32 v151, v151, v239
    v_mul_f32 v152, v152, v239
    v_mul_f32 v153, v153, v239
    v_mul_f32 v154, v154, v239
    v_mul_f32 v155, v155, v239
    v_mul_f32 v156, v156, v239
    v_mul_f32 v157, v157, v239
    v_mul_f32 v158, v158, v239
    v_mul_f32 v159, v159, v239
    v_mul_f32 v160, v160, v239
    v_mul_f32 v161, v161, v239
    v_mul_f32 v162, v162, v239
    v_mul_f32 v163, v163, v239
    v_mul_f32 v164, v164, v239
    v_mul_f32 v165, v165, v239
    v_mul_f32 v166, v166, v239
    v_mul_f32 v167, v167, v239
L_at_nors_7:
    v_mul_f32 v238, s24, v236
    v_fma_f32 v40, v40, s23, v238
    v_fma_f32 v41, v41, s23, v238
    v_fma_f32 v42, v42, s23, v238
    ds_read_b128 v[192:195], v218 offset:24576
    s_waitcnt lgkmcnt(7)
    v_mfma_f32_32x32x16_bf16 v[72:87], v[196:199], v[20:23], v[72:87]
    v_fma_f32 v43, v43, s23, v238
    v_fma_f32 v44, v44, s23, v238
    v_fma_f32 v45, v45, s23, v238
    v_fma_f32 v46, v46, s23, v238
    v_fma_f32 v47, v47, s23, v238
    v_fma_f32 v48, v48, s23, v238
    v_fma_f32 v49, v49, s23, v238
    v_fma_f32 v50, v50, s23, v238
    v_fma_f32 v51, v51, s23, v238
    ds_read_b128 v[196:199], v219 offset:24576
    s_waitcnt lgkmcnt(7)
    v_mfma_f32_32x32x16_bf16 v[72:87], v[200:203], v[24:27], v[72:87]
    v_fma_f32 v52, v52, s23, v238
    v_fma_f32 v53, v53, s23, v238
    v_fma_f32 v54, v54, s23, v238
    v_fma_f32 v55, v55, s23, v238
    v_fma_f32 v56, v56, s23, v238
    v_fma_f32 v57, v57, s23, v238
    v_fma_f32 v58, v58, s23, v238
    v_fma_f32 v59, v59, s23, v238
    v_fma_f32 v60, v60, s23, v238
    ds_read_b128 v[200:203], v220 offset:24576
    s_waitcnt lgkmcnt(7)
    v_mfma_f32_32x32x16_bf16 v[72:87], v[204:207], v[28:31], v[72:87]
    v_fma_f32 v61, v61, s23, v238
    v_fma_f32 v62, v62, s23, v238
    v_fma_f32 v63, v63, s23, v238
    v_fma_f32 v64, v64, s23, v238
    v_fma_f32 v65, v65, s23, v238
    v_fma_f32 v66, v66, s23, v238
    v_fma_f32 v67, v67, s23, v238
    v_fma_f32 v68, v68, s23, v238
    v_fma_f32 v69, v69, s23, v238
    ds_read_b128 v[204:207], v221 offset:24576
    s_waitcnt lgkmcnt(7)
    v_mfma_f32_32x32x16_bf16 v[72:87], v[208:211], v[32:35], v[72:87]
    v_fma_f32 v70, v70, s23, v238
    v_fma_f32 v71, v71, s23, v238
    v_exp_f32 v40, v40
    v_exp_f32 v41, v41
    v_exp_f32 v42, v42
    v_exp_f32 v43, v43
    v_exp_f32 v44, v44
    v_exp_f32 v45, v45
    v_exp_f32 v46, v46
    ds_read_b128 v[208:211], v222 offset:24576
    s_waitcnt lgkmcnt(7)
    v_mfma_f32_32x32x16_bf16 v[72:87], v[212:215], v[36:39], v[72:87]
    v_exp_f32 v47, v47
    v_exp_f32 v48, v48
    v_exp_f32 v49, v49
    v_exp_f32 v50, v50
    v_exp_f32 v51, v51
    v_exp_f32 v52, v52
    v_exp_f32 v53, v53
    v_exp_f32 v54, v54
    v_exp_f32 v55, v55
    ds_read_b128 v[212:215], v223 offset:24576
    s_waitcnt lgkmcnt(7)
    v_mfma_f32_32x32x16_bf16 v[88:103], v[184:187], v[8:11], 0
    v_exp_f32 v56, v56
    v_exp_f32 v57, v57
    v_exp_f32 v58, v58
    v_exp_f32 v59, v59
    v_exp_f32 v60, v60
    v_exp_f32 v61, v61
    v_exp_f32 v62, v62
    v_exp_f32 v63, v63
    v_exp_f32 v64, v64
    s_waitcnt lgkmcnt(6)
    v_mfma_f32_32x32x16_bf16 v[88:103], v[188:191], v[12:15], v[88:103]
    ds_read_b64_tr_b16 v[184:185], v224 offset:0
    ds_read_b64_tr_b16 v[186:187], v224 offset:2048
    v_exp_f32 v65, v65
    v_exp_f32 v66, v66
    v_exp_f32 v67, v67
    v_exp_f32 v68, v68
    v_exp_f32 v69, v69
    v_exp_f32 v70, v70
    v_exp_f32 v71, v71
    v_add_f32 v244, v40, v41
    v_add_f32 v245, v48, v49
    s_waitcnt lgkmcnt(7)
    v_mfma_f32_32x32x16_bf16 v[88:103], v[192:195], v[16:19], v[88:103]
    ds_read_b64_tr_b16 v[188:189], v224 offset:4096
    ds_read_b64_tr_b16 v[190:191], v224 offset:6144
    v_add_f32 v246, v56, v57
    v_add_f32 v247, v64, v65
    v_add_f32 v244, v244, v42
    v_add_f32 v245, v245, v50
    v_add_f32 v246, v246, v58
    v_add_f32 v247, v247, v66
    v_add_f32 v244, v244, v43
    v_add_f32 v245, v245, v51
    v_add_f32 v246, v246, v59
    s_waitcnt lgkmcnt(8)
    v_mfma_f32_32x32x16_bf16 v[88:103], v[196:199], v[20:23], v[88:103]
    ds_read_b64_tr_b16 v[192:193], v224 offset:8192
    ds_read_b64_tr_b16 v[194:195], v224 offset:10240
    v_add_f32 v247, v247, v67
    v_add_f32 v244, v244, v44
    v_add_f32 v245, v245, v52
    v_add_f32 v246, v246, v60
    v_add_f32 v247, v247, v68
    v_add_f32 v244, v244, v45
    v_add_f32 v245, v245, v53
    v_add_f32 v246, v246, v61
    v_add_f32 v247, v247, v69
    s_waitcnt lgkmcnt(9)
    v_mfma_f32_32x32x16_bf16 v[88:103], v[200:203], v[24:27], v[88:103]
    ds_read_b64_tr_b16 v[196:197], v224 offset:12288
    ds_read_b64_tr_b16 v[198:199], v224 offset:14336
    v_add_f32 v244, v244, v46
    v_add_f32 v245, v245, v54
    v_add_f32 v246, v246, v62
    v_add_f32 v247, v247, v70
    v_add_f32 v244, v244, v47
    v_add_f32 v245, v245, v55
    v_add_f32 v246, v246, v63
    v_add_f32 v247, v247, v71
    v_add_f32 v244, v244, v245
    s_waitcnt lgkmcnt(10)
    v_mfma_f32_32x32x16_bf16 v[88:103], v[204:207], v[28:31], v[88:103]
    ds_read_b64_tr_b16 v[200:201], v225 offset:0
    ds_read_b64_tr_b16 v[202:203], v225 offset:2048
    v_add_f32 v246, v246, v247
    v_add_f32 v244, v244, v246
    v_add_f32 v237, v237, v244
    v_cvt_pk_bf16_f32 v168, v40, v41
    v_cvt_pk_bf16_f32 v169, v42, v43
    v_cvt_pk_bf16_f32 v170, v44, v45
    v_cvt_pk_bf16_f32 v171, v46, v47
    v_cvt_pk_bf16_f32 v172, v48, v49
    v_cvt_pk_bf16_f32 v173, v50, v51
    s_waitcnt lgkmcnt(11)
    v_mfma_f32_32x32x16_bf16 v[88:103], v[208:211], v[32:35], v[88:103]
    ds_read_b64_tr_b16 v[204:205], v225 offset:4096
    ds_read_b64_tr_b16 v[206:207], v225 offset:6144
    v_cvt_pk_bf16_f32 v174, v52, v53
    v_cvt_pk_bf16_f32 v175, v54, v55
    v_cvt_pk_bf16_f32 v176, v56, v57
    v_cvt_pk_bf16_f32 v177, v58, v59
    v_cvt_pk_bf16_f32 v178, v60, v61
    v_cvt_pk_bf16_f32 v179, v62, v63
    v_cvt_pk_bf16_f32 v180, v64, v65
    v_cvt_pk_bf16_f32 v181, v66, v67
    v_cvt_pk_bf16_f32 v182, v68, v69
    s_waitcnt lgkmcnt(12)
    v_mfma_f32_32x32x16_bf16 v[88:103], v[212:215], v[36:39], v[88:103]
    ds_read_b64_tr_b16 v[208:209], v225 offset:8192
    ds_read_b64_tr_b16 v[210:211], v225 offset:10240
    v_cvt_pk_bf16_f32 v183, v70, v71
    ds_read_b64_tr_b16 v[212:213], v225 offset:12288
    ds_read_b64_tr_b16 v[214:215], v225 offset:14336
    s_waitcnt lgkmcnt(14)
    v_mfma_f32_32x32x16_bf16 v[104:119], v[184:187], v[168:171], v[104:119]
    ds_read_b64_tr_b16 v[184:185], v226 offset:0
    ds_read_b64_tr_b16 v[186:187], v226 offset:2048
    s_waitcnt lgkmcnt(14)
    v_mfma_f32_32x32x16_bf16 v[104:119], v[188:191], v[172:175], v[104:119]
    ds_read_b64_tr_b16 v[188:189], v226 offset:4096
    ds_read_b64_tr_b16 v[190:191], v226 offset:6144
    s_waitcnt lgkmcnt(14)
    v_mfma_f32_32x32x16_bf16 v[104:119], v[192:195], v[176:179], v[104:119]
    ds_read_b64_tr_b16 v[192:193], v226 offset:8192
    ds_read_b64_tr_b16 v[194:195], v226 offset:10240
    s_waitcnt lgkmcnt(14)
    v_mfma_f32_32x32x16_bf16 v[104:119], v[196:199], v[180:183], v[104:119]
    ds_read_b64_tr_b16 v[196:197], v226 offset:12288
    ds_read_b64_tr_b16 v[198:199], v226 offset:14336
    s_waitcnt lgkmcnt(14)
    v_mfma_f32_32x32x16_bf16 v[120:135], v[200:203], v[168:171], v[120:135]
    ds_read_b64_tr_b16 v[200:201], v227 offset:0
    ds_read_b64_tr_b16 v[202:203], v227 offset:2048
    s_waitcnt lgkmcnt(14)
    v_mfma_f32_32x32x16_bf16 v[120:135], v[204:207], v[172:175], v[120:135]
    ds_read_b64_tr_b16 v[204:205], v227 offset:4096
    ds_read_b64_tr_b16 v[206:207], v227 offset:6144
    s_waitcnt lgkmcnt(14)
    v_mfma_f32_32x32x16_bf16 v[120:135], v[208:211], v[176:179], v[120:135]
    ds_read_b64_tr_b16 v[208:209], v227 offset:8192
    ds_read_b64_tr_b16 v[210:211], v227 offset:10240
    s_waitcnt lgkmcnt(14)
    v_mfma_f32_32x32x16_bf16 v[120:135], v[212:215], v[180:183], v[120:135]
    ds_read_b64_tr_b16 v[212:213], v227 offset:12288
    ds_read_b64_tr_b16 v[214:215], v227 offset:14336
    s_waitcnt lgkmcnt(14)
    v_mfma_f32_32x32x16_bf16 v[136:151], v[184:187], v[168:171], v[136:151]
    s_waitcnt lgkmcnt(12)
    v_mfma_f32_32x32x16_bf16 v[136:151], v[188:191], v[172:175], v[136:151]
    s_waitcnt lgkmcnt(10)
    v_mfma_f32_32x32x16_bf16 v[136:151], v[192:195], v[176:179], v[136:151]
    s_waitcnt lgkmcnt(8)
    v_mfma_f32_32x32x16_bf16 v[136:151], v[196:199], v[180:183], v[136:151]
    s_waitcnt lgkmcnt(6)
    v_mfma_f32_32x32x16_bf16 v[152:167], v[200:203], v[168:171], v[152:167]
    s_waitcnt lgkmcnt(4)
    v_mfma_f32_32x32x16_bf16 v[152:167], v[204:207], v[172:175], v[152:167]
    s_waitcnt lgkmcnt(2)
    v_mfma_f32_32x32x16_bf16 v[152:167], v[208:211], v[176:179], v[152:167]
    s_waitcnt lgkmcnt(0)
    v_mfma_f32_32x32x16_bf16 v[152:167], v[212:215], v[180:183], v[152:167]
    s_waitcnt vmcnt(1)
    s_barrier
    s_add_u32 m0, s21, 0x4000
    s_nop 0
    buffer_load_dwordx4 v228, s[4:7], s30 offen lds
    s_add_u32 m0, s21, 0x5000
    s_nop 0
    buffer_load_dwordx4 v229, s[4:7], s30 offen lds
    s_add_u32 m0, s21, 0x6000
    s_nop 0
    buffer_load_dwordx4 v230, s[4:7], s30 offen lds
    s_add_u32 m0, s21, 0x7000
    s_nop 0
    buffer_load_dwordx4 v231, s[4:7], s30 offen lds
    s_add_u32 s30, s30, 0x4000
    s_add_u32 m0, s21, 0x8000
    s_nop 0
    buffer_load_dwordx4 v232, s[8:11], s20 offen lds
    s_add_u32 m0, s21, 0x9000
    s_nop 0
    buffer_load_dwordx4 v233, s[8:11], s20 offen lds
    s_add_u32 m0, s21, 0xa000
    s_nop 0
    buffer_load_dwordx4 v234, s[8:11], s20 offen lds
    s_add_u32 m0, s21, 0xb000
    s_nop 0
    buffer_load_dwordx4 v235, s[8:11], s20 offen lds
    s_add_u32 s20, s20, 0x4000
    s_mov_b32 m0, 0x10000
    s_nop 0
    buffer_load_dwordx4 v7, s[44:47], s53 offen lds
    s_add_u32 s53, s53, 0x400
    ds_read_b64_tr_b16 v[184:185], v224 offset:16384
    ds_read_b64_tr_b16 v[186:187], v224 offset:18432
    ds_read_b64_tr_b16 v[188:189], v224 offset:20480
    ds_read_b64_tr_b16 v[190:191], v224 offset:22528
    ds_read_b64_tr_b16 v[192:193], v224 offset:24576
    ds_read_b64_tr_b16 v[194:195], v224 offset:26624
    ds_read_b64_tr_b16 v[196:197], v224 offset:28672
    ds_read_b64_tr_b16 v[198:199], v224 offset:30720
    ds_read_b64_tr_b16 v[200:201], v225 offset:16384
    ds_read_b64_tr_b16 v[202:203], v225 offset:18432
    ds_read_b64_tr_b16 v[204:205], v225 offset:20480
    ds_read_b64_tr_b16 v[206:207], v225 offset:22528
    ds_read_b64_tr_b16 v[208:209], v225 offset:24576
    ds_read_b64_tr_b16 v[210:211], v225 offset:26624
    v_max3_f32 v240, v72, v73, v74
    v_max3_f32 v240, v240, v75, v76
    v_max3_f32 v240, v240, v77, v78
    v_max_f32 v240, v240, v79
    v_max3_f32 v241, v80, v81, v82
    v_max3_f32 v241, v241, v83, v84
    v_max3_f32 v241, v241, v85, v86
    v_max_f32 v241, v241, v87
    v_max3_f32 v242, v88, v89, v90
    v_max3_f32 v242, v242, v91, v92
    v_max3_f32 v242, v242, v93, v94
    v_max_f32 v242, v242, v95
    v_max3_f32 v243, v96, v97, v98
    v_max3_f32 v243, v243, v99, v100
    v_max3_f32 v243, v243, v101, v102
    v_max_f32 v243, v243, v103
    v_max3_f32 v240, v240, v241, v242
    v_max_f32 v240, v240, v243
    v_mov_b32 v241, v240
    s_nop 1
    v_permlane32_swap_b32 v240, v241
    v_max_f32 v240, v240, v241
    v_sub_f32 v241, v240, v236
    v_cmp_lt_f32 vcc, s31, v241
    s_nop 4
    s_cbranch_vccz L_at_nors_8
    v_max_f32 v241, v240, v236
    v_sub_f32 v239, v236, v241
    v_mul_f32 v239, s23, v239
    v_exp_f32 v239, v239
    v_mov_b32 v236, v241
    v_mul_f32 v237, v237, v239
    v_mul_f32 v104, v104, v239
    v_mul_f32 v105, v105, v239
    v_mul_f32 v106, v106, v239
    v_mul_f32 v107, v107, v239
    v_mul_f32 v108, v108, v239
    v_mul_f32 v109, v109, v239
    v_mul_f32 v110, v110, v239
    v_mul_f32 v111, v111, v239
    v_mul_f32 v112, v112, v239
    v_mul_f32 v113, v113, v239
    v_mul_f32 v114, v114, v239
    v_mul_f32 v115, v115, v239
    v_mul_f32 v116, v116, v239
    v_mul_f32 v117, v117, v239
    v_mul_f32 v118, v118, v239
    v_mul_f32 v119, v119, v239
    v_mul_f32 v120, v120, v239
    v_mul_f32 v121, v121, v239
    v_mul_f32 v122, v122, v239
    v_mul_f32 v123, v123, v239
    v_mul_f32 v124, v124, v239
    v_mul_f32 v125, v125, v239
    v_mul_f32 v126, v126, v239
    v_mul_f32 v127, v127, v239
    v_mul_f32 v128, v128, v239
    v_mul_f32 v129, v129, v239
    v_mul_f32 v130, v130, v239
    v_mul_f32 v131, v131, v239
    v_mul_f32 v132, v132, v239
    v_mul_f32 v133, v133, v239
    v_mul_f32 v134, v134, v239
    v_mul_f32 v135, v135, v239
    v_mul_f32 v136, v136, v239
    v_mul_f32 v137, v137, v239
    v_mul_f32 v138, v138, v239
    v_mul_f32 v139, v139, v239
    v_mul_f32 v140, v140, v239
    v_mul_f32 v141, v141, v239
    v_mul_f32 v142, v142, v239
    v_mul_f32 v143, v143, v239
    v_mul_f32 v144, v144, v239
    v_mul_f32 v145, v145, v239
    v_mul_f32 v146, v146, v239
    v_mul_f32 v147, v147, v239
    v_mul_f32 v148, v148, v239
    v_mul_f32 v149, v149, v239
    v_mul_f32 v150, v150, v239
    v_mul_f32 v151, v151, v239
    v_mul_f32 v152, v152, v239
    v_mul_f32 v153, v153, v239
    v_mul_f32 v154, v154, v239
    v_mul_f32 v155, v155, v239
    v_mul_f32 v156, v156, v239
    v_mul_f32 v157, v157, v239
    v_mul_f32 v158, v158, v239
    v_mul_f32 v159, v159, v239
    v_mul_f32 v160, v160, v239
    v_mul_f32 v161, v161, v239
    v_mul_f32 v162, v162, v239
    v_mul_f32 v163, v163, v239
    v_mul_f32 v164, v164, v239
    v_mul_f32 v165, v165, v239
    v_mul_f32 v166, v166, v239
    v_mul_f32 v167, v167, v239
L_at_nors_8:
    v_mul_f32 v238, s24, v236
    v_fma_f32 v72, v72, s23, v238
    v_fma_f32 v73, v73, s23, v238
    v_fma_f32 v74, v74, s23, v238
    v_fma_f32 v75, v75, s23, v238
    v_fma_f32 v76, v76, s23, v238
    v_fma_f32 v77, v77, s23, v238
    v_fma_f32 v78, v78, s23, v238
    v_fma_f32 v79, v79, s23, v238
    v_fma_f32 v80, v80, s23, v238
    v_fma_f32 v81, v81, s23, v238
    v_fma_f32 v82, v82, s23, v238
    v_fma_f32 v83, v83, s23, v238
    v_fma_f32 v84, v84, s23, v238
    v_fma_f32 v85, v85, s23, v238
    v_fma_f32 v86, v86, s23, v238
    v_fma_f32 v87, v87, s23, v238
    v_fma_f32 v88, v88, s23, v238
    v_fma_f32 v89, v89, s23, v238
    v_fma_f32 v90, v90, s23, v238
    v_fma_f32 v91, v91, s23, v238
    v_fma_f32 v92, v92, s23, v238
    v_fma_f32 v93, v93, s23, v238
    v_fma_f32 v94, v94, s23, v238
    v_fma_f32 v95, v95, s23, v238
    v_fma_f32 v96, v96, s23, v238
    v_fma_f32 v97, v97, s23, v238
    v_fma_f32 v98, v98, s23, v238
    v_fma_f32 v99, v99, s23, v238
    v_fma_f32 v100, v100, s23, v238
    v_fma_f32 v101, v101, s23, v238
    v_fma_f32 v102, v102, s23, v238
    v_fma_f32 v103, v103, s23, v238
    v_exp_f32 v72, v72
    v_exp_f32 v73, v73
    v_exp_f32 v74, v74
    v_exp_f32 v75, v75
    v_exp_f32 v76, v76
    v_exp_f32 v77, v77
    v_exp_f32 v78, v78
    v_exp_f32 v79, v79
    v_exp_f32 v80, v80
    v_exp_f32 v81, v81
    v_exp_f32 v82, v82
    v_exp_f32 v83, v83
    v_exp_f32 v84, v84
    v_exp_f32 v85, v85
    v_exp_f32 v86, v86
    v_exp_f32 v87, v87
    v_exp_f32 v88, v88
    v_exp_f32 v89, v89
    v_exp_f32 v90, v90
    v_exp_f32 v91, v91
    v_exp_f32 v92, v92
    v_exp_f32 v93, v93
    v_exp_f32 v94, v94
    v_exp_f32 v95, v95
    v_exp_f32 v96, v96
    v_exp_f32 v97, v97
    v_exp_f32 v98, v98
    v_exp_f32 v99, v99
    v_exp_f32 v100, v100
    v_exp_f32 v101, v101
    v_exp_f32 v102, v102
    v_exp_f32 v103, v103
    v_add_f32 v244, v72, v73
    v_add_f32 v245, v80, v81
    v_add_f32 v246, v88, v89
    v_add_f32 v247, v96, v97
    v_add_f32 v244, v244, v74
    v_add_f32 v245, v245, v82
    v_add_f32 v246, v246, v90
    v_add_f32 v247, v247, v98
    v_add_f32 v244, v244, v75
    v_add_f32 v245, v245, v83
    v_add_f32 v246, v246, v91
    v_add_f32 v247, v247, v99
    v_add_f32 v244, v244, v76
    v_add_f32 v245, v245, v84
    v_add_f32 v246, v246, v92
    v_add_f32 v247, v247, v100
    v_add_f32 v244, v244, v77
    v_add_f32 v245, v245, v85
    v_add_f32 v246, v246, v93
    v_add_f32 v247, v247, v101
    v_add_f32 v244, v244, v78
    v_add_f32 v245, v245, v86
    v_add_f32 v246, v246, v94
    v_add_f32 v247, v247, v102
    v_add_f32 v244, v244, v79
    v_add_f32 v245, v245, v87
    v_add_f32 v246, v246, v95
    v_add_f32 v247, v247, v103
    v_add_f32 v244, v244, v245
    v_add_f32 v246, v246, v247
    v_add_f32 v244, v244, v246
    v_add_f32 v237, v237, v244
    v_cvt_pk_bf16_f32 v168, v72, v73
    v_cvt_pk_bf16_f32 v169, v74, v75
    v_cvt_pk_bf16_f32 v170, v76, v77
    v_cvt_pk_bf16_f32 v171, v78, v79
    v_cvt_pk_bf16_f32 v172, v80, v81
    v_cvt_pk_bf16_f32 v173, v82, v83
    v_cvt_pk_bf16_f32 v174, v84, v85
    v_cvt_pk_bf16_f32 v175, v86, v87
    v_cvt_pk_bf16_f32 v176, v88, v89
    v_cvt_pk_bf16_f32 v177, v90, v91
    v_cvt_pk_bf16_f32 v178, v92, v93
    v_cvt_pk_bf16_f32 v179, v94, v95
    v_cvt_pk_bf16_f32 v180, v96, v97
    v_cvt_pk_bf16_f32 v181, v98, v99
    v_cvt_pk_bf16_f32 v182, v100, v101
    v_cvt_pk_bf16_f32 v183, v102, v103
    ds_read_b64_tr_b16 v[212:213], v225 offset:28672
    ds_read_b64_tr_b16 v[214:215], v225 offset:30720
    s_waitcnt lgkmcnt(14)
    v_mfma_f32_32x32x16_bf16 v[104:119], v[184:187], v[168:171], v[104:119]
    ds_read_b64_tr_b16 v[184:185], v226 offset:16384
    ds_read_b64_tr_b16 v[186:187], v226 offset:18432
    s_waitcnt lgkmcnt(14)
    v_mfma_f32_32x32x16_bf16 v[104:119], v[188:191], v[172:175], v[104:119]
    ds_read_b64_tr_b16 v[188:189], v226 offset:20480
    ds_read_b64_tr_b16 v[190:191], v226 offset:22528
    s_waitcnt lgkmcnt(14)
    v_mfma_f32_32x32x16_bf16 v[104:119], v[192:195], v[176:179], v[104:119]
    ds_read_b64_tr_b16 v[192:193], v226 offset:24576
    ds_read_b64_tr_b16 v[194:195], v226 offset:26624
    s_waitcnt lgkmcnt(14)
    v_mfma_f32_32x32x16_bf16 v[104:119], v[196:199], v[180:183], v[104:119]
    ds_read_b64_tr_b16 v[196:197], v226 offset:28672
    ds_read_b64_tr_b16 v[198:199], v226 offset:30720
    s_waitcnt lgkmcnt(14)
    v_mfma_f32_32x32x16_bf16 v[120:135], v[200:203], v[168:171], v[120:135]
    ds_read_b64_tr_b16 v[200:201], v227 offset:16384
    ds_read_b64_tr_b16 v[202:203], v227 offset:18432
    s_waitcnt lgkmcnt(14)
    v_mfma_f32_32x32x16_bf16 v[120:135], v[204:207], v[172:175], v[120:135]
    ds_read_b64_tr_b16 v[204:205], v227 offset:20480
    ds_read_b64_tr_b16 v[206:207], v227 offset:22528
    s_waitcnt lgkmcnt(14)
    v_mfma_f32_32x32x16_bf16 v[120:135], v[208:211], v[176:179], v[120:135]
    ds_read_b64_tr_b16 v[208:209], v227 offset:24576
    ds_read_b64_tr_b16 v[210:211], v227 offset:26624
    s_waitcnt lgkmcnt(14)
    v_mfma_f32_32x32x16_bf16 v[120:135], v[212:215], v[180:183], v[120:135]
    ds_read_b64_tr_b16 v[212:213], v227 offset:28672
    ds_read_b64_tr_b16 v[214:215], v227 offset:30720
    s_waitcnt lgkmcnt(14)
    v_mfma_f32_32x32x16_bf16 v[136:151], v[184:187], v[168:171], v[136:151]
    s_waitcnt lgkmcnt(12)
    v_mfma_f32_32x32x16_bf16 v[136:151], v[188:191], v[172:175], v[136:151]
    s_waitcnt lgkmcnt(10)
    v_mfma_f32_32x32x16_bf16 v[136:151], v[192:195], v[176:179], v[136:151]
    s_waitcnt lgkmcnt(8)
    v_mfma_f32_32x32x16_bf16 v[136:151], v[196:199], v[180:183], v[136:151]
    s_waitcnt lgkmcnt(6)
    v_mfma_f32_32x32x16_bf16 v[152:167], v[200:203], v[168:171], v[152:167]
    s_waitcnt lgkmcnt(4)
    v_mfma_f32_32x32x16_bf16 v[152:167], v[204:207], v[172:175], v[152:167]
    s_waitcnt lgkmcnt(2)
    v_mfma_f32_32x32x16_bf16 v[152:167], v[208:211], v[176:179], v[152:167]
    s_waitcnt lgkmcnt(0)
    v_mfma_f32_32x32x16_bf16 v[152:167], v[212:215], v[180:183], v[152:167]
    v_mov_b32 v240, v237
    s_nop 1
    v_permlane32_swap_b32 v237, v240
    v_add_f32 v237, v237, v240
    v_rcp_f32 v237, v237
    s_nop 0
    v_mul_f32 v104, v104, v237
    v_mul_f32 v105, v105, v237
    v_mul_f32 v106, v106, v237
    v_mul_f32 v107, v107, v237
    v_mul_f32 v108, v108, v237
    v_mul_f32 v109, v109, v237
    v_mul_f32 v110, v110, v237
    v_mul_f32 v111, v111, v237
    v_mul_f32 v112, v112, v237
    v_mul_f32 v113, v113, v237
    v_mul_f32 v114, v114, v237
    v_mul_f32 v115, v115, v237
    v_mul_f32 v116, v116, v237
    v_mul_f32 v117, v117, v237
    v_mul_f32 v118, v118, v237
    v_mul_f32 v119, v119, v237
    v_mul_f32 v120, v120, v237
    v_mul_f32 v121, v121, v237
    v_mul_f32 v122, v122, v237
    v_mul_f32 v123, v123, v237
    v_mul_f32 v124, v124, v237
    v_mul_f32 v125, v125, v237
    v_mul_f32 v126, v126, v237
    v_mul_f32 v127, v127, v237
    v_mul_f32 v128, v128, v237
    v_mul_f32 v129, v129, v237
    v_mul_f32 v130, v130, v237
    v_mul_f32 v131, v131, v237
    v_mul_f32 v132, v132, v237
    v_mul_f32 v133, v133, v237
    v_mul_f32 v134, v134, v237
    v_mul_f32 v135, v135, v237
    v_mul_f32 v136, v136, v237
    v_mul_f32 v137, v137, v237
    v_mul_f32 v138, v138, v237
    v_mul_f32 v139, v139, v237
    v_mul_f32 v140, v140, v237
    v_mul_f32 v141, v141, v237
    v_mul_f32 v142, v142, v237
    v_mul_f32 v143, v143, v237
    v_mul_f32 v144, v144, v237
    v_mul_f32 v145, v145, v237
    v_mul_f32 v146, v146, v237
    v_mul_f32 v147, v147, v237
    v_mul_f32 v148, v148, v237
    v_mul_f32 v149, v149, v237
    v_mul_f32 v150, v150, v237
    v_mul_f32 v151, v151, v237
    v_mul_f32 v152, v152, v237
    v_mul_f32 v153, v153, v237
    v_mul_f32 v154, v154, v237
    v_mul_f32 v155, v155, v237
    v_mul_f32 v156, v156, v237
    v_mul_f32 v157, v157, v237
    v_mul_f32 v158, v158, v237
    v_mul_f32 v159, v159, v237
    v_mul_f32 v160, v160, v237
    v_mul_f32 v161, v161, v237
    v_mul_f32 v162, v162, v237
    v_mul_f32 v163, v163, v237
    v_mul_f32 v164, v164, v237
    v_mul_f32 v165, v165, v237
    v_mul_f32 v166, v166, v237
    v_mul_f32 v167, v167, v237
    v_cvt_pk_bf16_f32 v40, v104, v105
    v_cvt_pk_bf16_f32 v41, v106, v107
    v_cvt_pk_bf16_f32 v42, v108, v109
    v_cvt_pk_bf16_f32 v43, v110, v111
    v_cvt_pk_bf16_f32 v44, v112, v113
    v_cvt_pk_bf16_f32 v45, v114, v115
    v_cvt_pk_bf16_f32 v46, v116, v117
    v_cvt_pk_bf16_f32 v47, v118, v119
    v_permlane32_swap_b32 v40, v42
    v_permlane32_swap_b32 v41, v43
    v_permlane32_swap_b32 v44, v46
    v_permlane32_swap_b32 v45, v47
    buffer_store_dwordx4 v[40:43], v248, s[16:19], 0 offen offset:0
    buffer_store_dwordx4 v[44:47], v248, s[16:19], 0 offen offset:32
    v_cvt_pk_bf16_f32 v48, v120, v121
    v_cvt_pk_bf16_f32 v49, v122, v123
    v_cvt_pk_bf16_f32 v50, v124, v125
    v_cvt_pk_bf16_f32 v51, v126, v127
    v_cvt_pk_bf16_f32 v52, v128, v129
    v_cvt_pk_bf16_f32 v53, v130, v131
    v_cvt_pk_bf16_f32 v54, v132, v133
    v_cvt_pk_bf16_f32 v55, v134, v135
    v_permlane32_swap_b32 v48, v50
    v_permlane32_swap_b32 v49, v51
    v_permlane32_swap_b32 v52, v54
    v_permlane32_swap_b32 v53, v55
    buffer_store_dwordx4 v[48:51], v248, s[16:19], 0 offen offset:64
    buffer_store_dwordx4 v[52:55], v248, s[16:19], 0 offen offset:96
    v_cvt_pk_bf16_f32 v40, v136, v137
    v_cvt_pk_bf16_f32 v41, v138, v139
    v_cvt_pk_bf16_f32 v42, v140, v141
    v_cvt_pk_bf16_f32 v43, v142, v143
    v_cvt_pk_bf16_f32 v44, v144, v145
    v_cvt_pk_bf16_f32 v45, v146, v147
    v_cvt_pk_bf16_f32 v46, v148, v149
    v_cvt_pk_bf16_f32 v47, v150, v151
    v_permlane32_swap_b32 v40, v42
    v_permlane32_swap_b32 v41, v43
    v_permlane32_swap_b32 v44, v46
    v_permlane32_swap_b32 v45, v47
    buffer_store_dwordx4 v[40:43], v248, s[16:19], 0 offen offset:128
    buffer_store_dwordx4 v[44:47], v248, s[16:19], 0 offen offset:160
    v_cvt_pk_bf16_f32 v48, v152, v153
    v_cvt_pk_bf16_f32 v49, v154, v155
    v_cvt_pk_bf16_f32 v50, v156, v157
    v_cvt_pk_bf16_f32 v51, v158, v159
    v_cvt_pk_bf16_f32 v52, v160, v161
    v_cvt_pk_bf16_f32 v53, v162, v163
    v_cvt_pk_bf16_f32 v54, v164, v165
    v_cvt_pk_bf16_f32 v55, v166, v167
    v_permlane32_swap_b32 v48, v50
    v_permlane32_swap_b32 v49, v51
    v_permlane32_swap_b32 v52, v54
    v_permlane32_swap_b32 v53, v55
    buffer_store_dwordx4 v[48:51], v248, s[16:19], 0 offen offset:192
    buffer_store_dwordx4 v[52:55], v248, s[16:19], 0 offen offset:224
L_at_end:
    s_endpgm
.section .rodata,"a"
.p2align 6
.amdhsa_kernel attn_kernel
  .amdhsa_next_free_vgpr 249
  .amdhsa_next_free_sgpr 54
  .amdhsa_accum_offset 252
  .amdhsa_group_segment_fixed_size 0
  .amdhsa_kernarg_size 88
  .amdhsa_user_sgpr_count 2
  .amdhsa_user_sgpr_kernarg_segment_ptr 1
  .amdhsa_system_sgpr_workgroup_id_x 1
.end_amdhsa_kernel
.text
.globl gemm2_kernel
.p2align 8
.type gemm2_kernel,@function
gemm2_kernel:
    s_load_dwordx2 s[32:33], s[0:1], 32
    s_load_dwordx2 s[34:35], s[0:1], 56
    s_load_dwordx2 s[36:37], s[0:1], 80
    s_cmp_ge_u32 s2, 256
    s_cbranch_scc1 L_g2_end
    s_and_b32 s40, s2, 7
    s_lshr_b32 s41, s2, 3
    s_lshr_b32 s42, s41, 4
    s_and_b32 s41, s41, 15
    s_lshr_b32 s43, s41, 2
    s_and_b32 s44, s41, 3
    s_lshr_b32 s45, s40, 1
    s_lshl_b32 s45, s45, 2
    s_add_u32 s43, s43, s45
    s_and_b32 s45, s40, 1
    s_lshl_b32 s45, s45, 2
    s_add_u32 s44, s44, s45
    s_lshl_b32 s43, s43, 7
    s_lshl_b32 s44, s44, 7
    s_waitcnt lgkmcnt(0)
    s_cmp_eq_u32 s42, 0
    s_cselect_b64 s[46:47], s[32:33], s[34:35]
    s_movk_i32 s48, 8192
    s_movk_i32 s49, 7168
    s_cselect_b32 s16, s48, s49
    s_mov_b32 s48, 0x2400000
    s_mov_b32 s49, 0x1400000
    s_cselect_b32 s48, s48, s49
    s_mov_b32 s50, 0x3400000
    s_mov_b32 s51, 0x3800000
    s_cselect_b32 s50, s50, s51
    s_movk_i32 s51, 15
    s_movk_i32 s52, 13
    s_cselect_b32 s20, s51, s52
    s_movk_i32 s17, 2048
    s_movk_i32 s26, 2048
    s_add_u32 s4, s36, s48
    s_addc_u32 s5, s37, 0
    s_lshl_b32 s6, s16, 11
    s_mov_b32 s7, 0x00020000
    s_mov_b32 s8, s46
    s_mov_b32 s9, s47
    s_lshl_b32 s10, s16, 10
    s_mov_b32 s11, 0x00020000
    s_add_u32 s12, s36, s50
    s_addc_u32 s13, s37, 0
    s_mov_b32 s14, 0x400000
    s_mov_b32 s15, 0x00020000
    s_mul_i32 s18, s43, s16
    s_lshl_b32 s19, s44, 1
    s_lshl_b32 s27, s43, 11
    s_add_u32 s27, s27, s19
    v_lshrrev_b32 v1, 6, v0
    s_nop 0
    v_readfirstlane_b32 s23, v1
    v_and_b32 v2, 63, v0
    s_nop 1
    s_lshl_b32 s21, s23, 10
    s_lshr_b32 s29, s23, 1
    s_mul_i32 s24, s29, 64
    s_and_b32 s29, s23, 1
    s_mul_i32 s25, s29, 64
    v_lshrrev_b32 v3, 3, v2
    s_lshl_b32 s29, s23, 3
    v_add_u32 v3, s29, v3
    v_lshrrev_b32 v4, 4, v2
    s_and_b32 s29, s23, 1
    s_lshl_b32 s29, s29, 2
    v_or_b32 v4, s29, v4
    v_and_b32 v5, 7, v2
    v_xor_b32 v5, v5, v4
    v_lshlrev_b32 v5, 4, v5
    v_mad_u32_u24 v14, v3, s16, v5
    s_lshl_b32 s29, s16, 5
    v_add_u32 v15, s29, v14
    v_add_u32 v16, s29, v15
    v_add_u32 v17, s29, v16
    v_lshrrev_b32 v3, 4, v2
    s_mul_i32 s29, s23, 4
    v_add_u32 v3, s29, v3
    v_and_b32 v5, 15, v2
    v_add_u32 v4, 0, v3
    v_and_b32 v6, 3, v4
    v_lshlrev_b32 v6, 2, v6
    v_lshrrev_b32 v7, 2, v4
    v_and_b32 v7, 2, v7
    v_or_b32 v6, v6, v7
    v_xor_b32 v6, v5, v6
    v_lshlrev_b32 v6, 4, v6
    v_mad_u32_u24 v18, v4, s17, v6
    v_add_u32 v4, 16, v3
    v_and_b32 v6, 3, v4
    v_lshlrev_b32 v6, 2, v6
    v_lshrrev_b32 v7, 2, v4
    v_and_b32 v7, 2, v7
    v_or_b32 v6, v6, v7
    v_xor_b32 v6, v5, v6
    v_lshlrev_b32 v6, 4, v6
    v_mad_u32_u24 v19, v4, s17, v6
    v_add_u32 v4, 32, v3
    v_and_b32 v6, 3, v4
    v_lshlrev_b32 v6, 2, v6
    v_lshrrev_b32 v7, 2, v4
    v_and_b32 v7, 2, v7
    v_or_b32 v6, v6, v7
    v_xor_b32 v6, v5, v6
    v_lshlrev_b32 v6, 4, v6
    v_mad_u32_u24 v20, v4, s17, v6
    v_add_u32 v4, 48, v3
    v_and_b32 v6, 3, v4
    v_lshlrev_b32 v6, 2, v6
    v_lshrrev_b32 v7, 2, v4
    v_and_b32 v7, 2, v7
    v_or_b32 v6, v6, v7
    v_xor_b32 v6, v5, v6
    v_lshlrev_b32 v6, 4, v6
    v_mad_u32_u24 v21, v4, s17, v6
    s_lshl_b32 s22, s17, 6
    v_and_b32 v3, 15, v2
    v_add_u32 v3, s24, v3
    v_lshlrev_b32 v3, 7, v3
    v_lshrrev_b32 v4, 4, v2
    v_bfe_u32 v5, v2, 1, 3
    v_xor_b32 v4, v4, v5
    v_xor_b32 v5, 0, v4
    v_lshl_add_u32 v8, v5, 4, v3
    v_xor_b32 v5, 4, v4
    v_lshl_add_u32 v9, v5, 4, v3
    v_lshrrev_b32 v3, 4, v2
    v_bfe_u32 v4, v2, 2, 2
    v_lshl_add_u32 v5, v3, 3, v4
    v_lshlrev_b32 v5, 8, v5
    v_and_b32 v6, 1, v2
    v_lshl_add_u32 v5, v6, 3, v5
    v_add_u32 v5, 0x10000, v5
    v_lshlrev_b32 v4, 2, v4
    v_and_b32 v3, 1, v3
    v_lshl_or_b32 v4, v3, 1, v4
    v_bfe_u32 v6, v2, 1, 1
    s_lshr_b32 s29, s25, 3
    s_add_u32 s30, s29, 0
    v_xor_b32 v7, s30, v4
    v_add_u32 v7, v7, v6
    v_lshl_add_u32 v10, v7, 4, v5
    s_add_u32 s30, s29, 2
    v_xor_b32 v7, s30, v4
    v_add_u32 v7, v7, v6
    v_lshl_add_u32 v11, v7, 4, v5
    s_add_u32 s30, s29, 4
    v_xor_b32 v7, s30, v4
    v_add_u32 v7, v7, v6
    v_lshl_add_u32 v12, v7, 4, v5
    s_add_u32 s30, s29, 6
    v_xor_b32 v7, s30, v4
    v_add_u32 v7, v7, v6
    v_lshl_add_u32 v13, v7, 4, v5
    v_and_b32 v3, 15, v2
    v_add_u32 v3, s24, v3
    v_bfe_u32 v4, v2, 4, 1
    v_lshlrev_b32 v4, 5, v4
    v_bfe_u32 v5, v2, 5, 1
    v_lshl_add_u32 v4, v5, 4, v4
    s_lshl_b32 s29, s25, 1
    v_add_u32 v4, s29, v4
    v_mad_u32_u24 v22, v3, s26, v4
    s_lshl_b32 s29, s26, 4
    v_add_u32 v23, s29, v22
    v_add_u32 v24, s29, v23
    v_add_u32 v25, s29, v24
    s_add_u32 m0, s21, 0x0
    s_nop 0
    buffer_load_dwordx4 v14, s[4:7], s18 offen lds
    s_add_u32 m0, s21, 0x1000
    s_nop 0
    buffer_load_dwordx4 v15, s[4:7], s18 offen lds
    s_add_u32 m0, s21, 0x2000
    s_nop 0
    buffer_load_dwordx4 v16, s[4:7], s18 offen lds
    s_add_u32 m0, s21, 0x3000
    s_nop 0
    buffer_load_dwordx4 v17, s[4:7], s18 offen lds
    s_add_u32 m0, s21, 0x10000
    s_nop 0
    buffer_load_dwordx4 v18, s[8:11], s19 offen lds
    s_add_u32 m0, s21, 0x11000
    s_nop 0
    buffer_load_dwordx4 v19, s[8:11], s19 offen lds
    s_add_u32 m0, s21, 0x12000
    s_nop 0
    buffer_load_dwordx4 v20, s[8:11], s19 offen lds
    s_add_u32 m0, s21, 0x13000
    s_nop 0
    buffer_load_dwordx4 v21, s[8:11], s19 offen lds
    s_add_u32 s18, s18, 128
    s_add_u32 s19, s19, s22
    s_add_u32 m0, s21, 0x4000
    s_nop 0
    buffer_load_dwordx4 v14, s[4:7], s18 offen lds
    s_add_u32 m0, s21, 0x5000
    s_nop 0
    buffer_load_dwordx4 v15, s[4:7], s18 offen lds
    s_add_u32 m0, s21, 0x6000
    s_nop 0
    buffer_load_dwordx4 v16, s[4:7], s18 offen lds
    s_add_u32 m0, s21, 0x7000
    s_nop 0
    buffer_load_dwordx4 v17, s[4:7], s18 offen lds
    s_add_u32 m0, s21, 0x14000
    s_nop 0
    buffer_load_dwordx4 v18, s[8:11], s19 offen lds
    s_add_u32 m0, s21, 0x15000
    s_nop 0
    buffer_load_dwordx4 v19, s[8:11], s19 offen lds
    s_add_u32 m0, s21, 0x16000
    s_nop 0
    buffer_load_dwordx4 v20, s[8:11], s19 offen lds
    s_add_u32 m0, s21, 0x17000
    s_nop 0
    buffer_load_dwordx4 v21, s[8:11], s19 offen lds
    s_add_u32 s18, s18, 128
    s_add_u32 s19, s19, s22
    s_add_u32 m0, s21, 0x8000
    s_nop 0
    buffer_load_dwordx4 v14, s[4:7], s18 offen lds
    s_add_u32 m0, s21, 0x9000
    s_nop 0
    buffer_load_dwordx4 v15, s[4:7], s18 offen lds
    s_add_u32 m0, s21, 0xa000
    s_nop 0
    buffer_load_dwordx4 v16, s[4:7], s18 offen lds
    s_add_u32 m0, s21, 0xb000
    s_nop 0
    buffer_load_dwordx4 v17, s[4:7], s18 offen lds
    s_add_u32 m0, s21, 0x18000
    s_nop 0
    buffer_load_dwordx4 v18, s[8:11], s19 offen lds
    s_add_u32 m0, s21, 0x19000
    s_nop 0
    buffer_load_dwordx4 v19, s[8:11], s19 offen lds
    s_add_u32 m0, s21, 0x1a000
    s_nop 0
    buffer_load_dwordx4 v20, s[8:11], s19 offen lds
    s_add_u32 m0, s21, 0x1b000
    s_nop 0
    buffer_load_dwordx4 v21, s[8:11], s19 offen lds
    s_add_u32 s18, s18, 128
    s_add_u32 s19, s19, s22
    s_waitcnt lgkmcnt(0)
    s_waitcnt vmcnt(16)
    s_barrier
    s_add_u32 m0, s21, 0xc000
    ds_read_b64_tr_b16 v[60:61], v10 offset:0
    buffer_load_dwordx4 v14, s[4:7], s18 offen lds
    s_add_u32 m0, s21, 0xd000
    ds_read_b64_tr_b16 v[62:63], v10 offset:1024
    buffer_load_dwordx4 v15, s[4:7], s18 offen lds
    s_add_u32 m0, s21, 0xe000
    ds_read_b128 v[28:31], v8 offset:0
    buffer_load_dwordx4 v16, s[4:7], s18 offen lds
    s_add_u32 m0, s21, 0xf000
    ds_read_b128 v[32:35], v8 offset:2048
    buffer_load_dwordx4 v17, s[4:7], s18 offen lds
    ds_read_b128 v[36:39], v8 offset:4096
    ds_read_b128 v[40:43], v8 offset:6144
    ds_read_b64_tr_b16 v[64:65], v11 offset:0
    ds_read_b64_tr_b16 v[66:67], v11 offset:1024
    ds_read_b64_tr_b16 v[68:69], v12 offset:0
    ds_read_b64_tr_b16 v[70:71], v12 offset:1024
    ds_read_b64_tr_b16 v[72:73], v13 offset:0
    ds_read_b64_tr_b16 v[74:75], v13 offset:1024
    s_waitcnt lgkmcnt(9)
    v_mfma_f32_16x16x32_bf16 v[92:95], v[60:63], v[28:31], 0
    s_add_u32 m0, s21, 0x1c000
    ds_read_b64_tr_b16 v[76:77], v10 offset:8192
    s_waitcnt lgkmcnt(9)
    v_mfma_f32_16x16x32_bf16 v[96:99], v[60:63], v[32:35], 0
    buffer_load_dwordx4 v18, s[8:11], s19 offen lds
    s_add_u32 m0, s21, 0x1d000
    s_waitcnt lgkmcnt(8)
    v_mfma_f32_16x16x32_bf16 v[100:103], v[60:63], v[36:39], 0
    ds_read_b64_tr_b16 v[78:79], v10 offset:9216
    buffer_load_dwordx4 v19, s[8:11], s19 offen lds
    s_waitcnt lgkmcnt(8)
    v_mfma_f32_16x16x32_bf16 v[104:107], v[60:63], v[40:43], 0
    s_add_u32 m0, s21, 0x1e000
    ds_read_b128 v[44:47], v9 offset:0
    s_waitcnt lgkmcnt(7)
    v_mfma_f32_16x16x32_bf16 v[108:111], v[64:67], v[28:31], 0
    buffer_load_dwordx4 v20, s[8:11], s19 offen lds
    s_add_u32 m0, s21, 0x1f000
    v_mfma_f32_16x16x32_bf16 v[112:115], v[64:67], v[32:35], 0
    ds_read_b128 v[48:51], v9 offset:2048
    buffer_load_dwordx4 v21, s[8:11], s19 offen lds
    v_mfma_f32_16x16x32_bf16 v[116:119], v[64:67], v[36:39], 0
    s_add_u32 s18, s18, 128
    s_add_u32 s19, s19, s22
    v_mfma_f32_16x16x32_bf16 v[120:123], v[64:67], v[40:43], 0
    ds_read_b128 v[52:55], v9 offset:4096
    ds_read_b128 v[56:59], v9 offset:6144
    s_waitcnt lgkmcnt(8)
    v_mfma_f32_16x16x32_bf16 v[124:127], v[68:71], v[28:31], 0
    ds_read_b64_tr_b16 v[80:81], v11 offset:8192
    ds_read_b64_tr_b16 v[82:83], v11 offset:9216
    v_mfma_f32_16x16x32_bf16 v[128:131], v[68:71], v[32:35], 0
    ds_read_b64_tr_b16 v[84:85], v12 offset:8192
    ds_read_b64_tr_b16 v[86:87], v12 offset:9216
    v_mfma_f32_16x16x32_bf16 v[132:135], v[68:71], v[36:39], 0
    ds_read_b64_tr_b16 v[88:89], v13 offset:8192
    ds_read_b64_tr_b16 v[90:91], v13 offset:9216
    v_mfma_f32_16x16x32_bf16 v[136:139], v[68:71], v[40:43], 0
    s_waitcnt lgkmcnt(12)
    v_mfma_f32_16x16x32_bf16 v[140:143], v[72:75], v[28:31], 0
    v_mfma_f32_16x16x32_bf16 v[144:147], v[72:75], v[32:35], 0
    v_mfma_f32_16x16x32_bf16 v[148:151], v[72:75], v[36:39], 0
    v_mfma_f32_16x16x32_bf16 v[152:155], v[72:75], v[40:43], 0
    s_waitcnt lgkmcnt(9)
    v_mfma_f32_16x16x32_bf16 v[92:95], v[76:79], v[44:47], v[92:95]
    s_waitcnt lgkmcnt(8)
    v_mfma_f32_16x16x32_bf16 v[96:99], v[76:79], v[48:51], v[96:99]
    s_waitcnt lgkmcnt(0)
    s_waitcnt vmcnt(16)
    s_barrier
    v_mfma_f32_16x16x32_bf16 v[100:103], v[76:79], v[52:55], v[100:103]
    s_add_u32 m0, s21, 0x0
    ds_read_b64_tr_b16 v[60:61], v10 offset:16384
    v_mfma_f32_16x16x32_bf16 v[104:107], v[76:79], v[56:59], v[104:107]
    buffer_load_dwordx4 v14, s[4:7], s18 offen lds
    s_add_u32 m0, s21, 0x1000
    v_mfma_f32_16x16x32_bf16 v[108:111], v[80:83], v[44:47], v[108:111]
    ds_read_b64_tr_b16 v[62:63], v10 offset:17408
    buffer_load_dwordx4 v15, s[4:7], s18 offen lds
    v_mfma_f32_16x16x32_bf16 v[112:115], v[80:83], v[48:51], v[112:115]
    s_add_u32 m0, s21, 0x2000
    ds_read_b128 v[28:31], v8 offset:16384
    v_mfma_f32_16x16x32_bf16 v[116:119], v[80:83], v[52:55], v[116:119]
    buffer_load_dwordx4 v16, s[4:7], s18 offen lds
    s_add_u32 m0, s21, 0x3000
    v_mfma_f32_16x16x32_bf16 v[120:123], v[80:83], v[56:59], v[120:123]
    ds_read_b128 v[32:35], v8 offset:18432
    buffer_load_dwordx4 v17, s[4:7], s18 offen lds
    v_mfma_f32_16x16x32_bf16 v[124:127], v[84:87], v[44:47], v[124:127]
    ds_read_b128 v[36:39], v8 offset:20480
    ds_read_b128 v[40:43], v8 offset:22528
    v_mfma_f32_16x16x32_bf16 v[128:131], v[84:87], v[48:51], v[128:131]
    ds_read_b64_tr_b16 v[64:65], v11 offset:16384
    ds_read_b64_tr_b16 v[66:67], v11 offset:17408
    v_mfma_f32_16x16x32_bf16 v[132:135], v[84:87], v[52:55], v[132:135]
    ds_read_b64_tr_b16 v[68:69], v12 offset:16384
    ds_read_b64_tr_b16 v[70:71], v12 offset:17408
    v_mfma_f32_16x16x32_bf16 v[136:139], v[84:87], v[56:59], v[136:139]
    ds_read_b64_tr_b16 v[72:73], v13 offset:16384
    ds_read_b64_tr_b16 v[74:75], v13 offset:17408
    v_mfma_f32_16x16x32_bf16 v[140:143], v[88:91], v[44:47], v[140:143]
    v_mfma_f32_16x16x32_bf16 v[144:147], v[88:91], v[48:51], v[144:147]
    v_mfma_f32_16x16x32_bf16 v[148:151], v[88:91], v[52:55], v[148:151]
    v_mfma_f32_16x16x32_bf16 v[152:155], v[88:91], v[56:59], v[152:155]
    s_waitcnt lgkmcnt(9)
    v_mfma_f32_16x16x32_bf16 v[92:95], v[60:63], v[28:31], v[92:95]
    s_add_u32 m0, s21, 0x10000
    ds_read_b64_tr_b16 v[76:77], v10 offset:24576
    s_waitcnt lgkmcnt(9)
    v_mfma_f32_16x16x32_bf16 v[96:99], v[60:63], v[32:35], v[96:99]
    buffer_load_dwordx4 v18, s[8:11], s19 offen lds
    s_add_u32 m0, s21, 0x11000
    s_waitcnt lgkmcnt(8)
    v_mfma_f32_16x16x32_bf16 v[100:103], v[60:63], v[36:39], v[100:103]
    ds_read_b64_tr_b16 v[78:79], v10 offset:25600
    buffer_load_dwordx4 v19, s[8:11], s19 offen lds
    s_waitcnt lgkmcnt(8)
    v_mfma_f32_16x16x32_bf16 v[104:107], v[60:63], v[40:43], v[104:107]
    s_add_u32 m0, s21, 0x12000
    ds_read_b128 v[44:47], v9 offset:16384
    s_waitcnt lgkmcnt(7)
    v_mfma_f32_16x16x32_bf16 v[108:111], v[64:67], v[28:31], v[108:111]
    buffer_load_dwordx4 v20, s[8:11], s19 offen lds
    s_add_u32 m0, s21, 0x13000
    v_mfma_f32_16x16x32_bf16 v[112:115], v[64:67], v[32:35], v[112:115]
    ds_read_b128 v[48:51], v9 offset:18432
    buffer_load_dwordx4 v21, s[8:11], s19 offen lds
    v_mfma_f32_16x16x32_bf16 v[116:119], v[64:67], v[36:39], v[116:119]
    s_add_u32 s18, s18, 128
    s_add_u32 s19, s19, s22
    v_mfma_f32_16x16x32_bf16 v[120:123], v[64:67], v[40:43], v[120:123]
    ds_read_b128 v[52:55], v9 offset:20480
    ds_read_b128 v[56:59], v9 offset:22528
    s_waitcnt lgkmcnt(8)
    v_mfma_f32_16x16x32_bf16 v[124:127], v[68:71], v[28:31], v[124:127]
    ds_read_b64_tr_b16 v[80:81], v11 offset:24576
    ds_read_b64_tr_b16 v[82:83], v11 offset:25600
    v_mfma_f32_16x16x32_bf16 v[128:131], v[68:71], v[32:35], v[128:131]
    ds_read_b64_tr_b16 v[84:85], v12 offset:24576
    ds_read_b64_tr_b16 v[86:87], v12 offset:25600
    v_mfma_f32_16x16x32_bf16 v[132:135], v[68:71], v[36:39], v[132:135]
    ds_read_b64_tr_b16 v[88:89], v13 offset:24576
    ds_read_b64_tr_b16 v[90:91], v13 offset:25600
    v_mfma_f32_16x16x32_bf16 v[136:139], v[68:71], v[40:43], v[136:139]
    s_waitcnt lgkmcnt(12)
    v_mfma_f32_16x16x32_bf16 v[140:143], v[72:75], v[28:31], v[140:143]
    v_mfma_f32_16x16x32_bf16 v[144:147], v[72:75], v[32:35], v[144:147]
    v_mfma_f32_16x16x32_bf16 v[148:151], v[72:75], v[36:39], v[148:151]
    v_mfma_f32_16x16x32_bf16 v[152:155], v[72:75], v[40:43], v[152:155]
    s_waitcnt lgkmcnt(9)
    v_mfma_f32_16x16x32_bf16 v[92:95], v[76:79], v[44:47], v[92:95]
    s_waitcnt lgkmcnt(8)
    v_mfma_f32_16x16x32_bf16 v[96:99], v[76:79], v[48:51], v[96:99]
    s_waitcnt lgkmcnt(0)
    s_waitcnt vmcnt(16)
    s_barrier
    v_mfma_f32_16x16x32_bf16 v[100:103], v[76:79], v[52:55], v[100:103]
    s_add_u32 m0, s21, 0x4000
    ds_read_b64_tr_b16 v[60:61], v10 offset:32768
    v_mfma_f32_16x16x32_bf16 v[104:107], v[76:79], v[56:59], v[104:107]
    buffer_load_dwordx4 v14, s[4:7], s18 offen lds
    s_add_u32 m0, s21, 0x5000
    v_mfma_f32_16x16x32_bf16 v[108:111], v[80:83], v[44:47], v[108:111]
    ds_read_b64_tr_b16 v[62:63], v10 offset:33792
    buffer_load_dwordx4 v15, s[4:7], s18 offen lds
    v_mfma_f32_16x16x32_bf16 v[112:115], v[80:83], v[48:51], v[112:115]
    s_add_u32 m0, s21, 0x6000
    ds_read_b128 v[28:31], v8 offset:32768
    v_mfma_f32_16x16x32_bf16 v[116:119], v[80:83], v[52:55], v[116:119]
    buffer_load_dwordx4 v16, s[4:7], s18 offen lds
    s_add_u32 m0, s21, 0x7000
    v_mfma_f32_16x16x32_bf16 v[120:123], v[80:83], v[56:59], v[120:123]
    ds_read_b128 v[32:35], v8 offset:34816
    buffer_load_dwordx4 v17, s[4:7], s18 offen lds
    v_mfma_f32_16x16x32_bf16 v[124:127], v[84:87], v[44:47], v[124:127]
    ds_read_b128 v[36:39], v8 offset:36864
    ds_read_b128 v[40:43], v8 offset:38912
    v_mfma_f32_16x16x32_bf16 v[128:131], v[84:87], v[48:51], v[128:131]
    ds_read_b64_tr_b16 v[64:65], v11 offset:32768
    ds_read_b64_tr_b16 v[66:67], v11 offset:33792
    v_mfma_f32_16x16x32_bf16 v[132:135], v[84:87], v[52:55], v[132:135]
    ds_read_b64_tr_b16 v[68:69], v12 offset:32768
    ds_read_b64_tr_b16 v[70:71], v12 offset:33792
    v_mfma_f32_16x16x32_bf16 v[136:139], v[84:87], v[56:59], v[136:139]
    ds_read_b64_tr_b16 v[72:73], v13 offset:32768
    ds_read_b64_tr_b16 v[74:75], v13 offset:33792
    v_mfma_f32_16x16x32_bf16 v[140:143], v[88:91], v[44:47], v[140:143]
    v_mfma_f32_16x16x32_bf16 v[144:147], v[88:91], v[48:51], v[144:147]
    v_mfma_f32_16x16x32_bf16 v[148:151], v[88:91], v[52:55], v[148:151]
    v_mfma_f32_16x16x32_bf16 v[152:155], v[88:91], v[56:59], v[152:155]
    s_waitcnt lgkmcnt(9)
    v_mfma_f32_16x16x32_bf16 v[92:95], v[60:63], v[28:31], v[92:95]
    s_add_u32 m0, s21, 0x14000
    ds_read_b64_tr_b16 v[76:77], v10 offset:40960
    s_waitcnt lgkmcnt(9)
    v_mfma_f32_16x16x32_bf16 v[96:99], v[60:63], v[32:35], v[96:99]
    buffer_load_dwordx4 v18, s[8:11], s19 offen lds
    s_add_u32 m0, s21, 0x15000
    s_waitcnt lgkmcnt(8)
    v_mfma_f32_16x16x32_bf16 v[100:103], v[60:63], v[36:39], v[100:103]
    ds_read_b64_tr_b16 v[78:79], v10 offset:41984
    buffer_load_dwordx4 v19, s[8:11], s19 offen lds
    s_waitcnt lgkmcnt(8)
    v_mfma_f32_16x16x32_bf16 v[104:107], v[60:63], v[40:43], v[104:107]
    s_add_u32 m0, s21, 0x16000
    ds_read_b128 v[44:47], v9 offset:32768
    s_waitcnt lgkmcnt(7)
    v_mfma_f32_16x16x32_bf16 v[108:111], v[64:67], v[28:31], v[108:111]
    buffer_load_dwordx4 v20, s[8:11], s19 offen lds
    s_add_u32 m0, s21, 0x17000
    v_mfma_f32_16x16x32_bf16 v[112:115], v[64:67], v[32:35], v[112:115]
    ds_read_b128 v[48:51], v9 offset:34816
    buffer_load_dwordx4 v21, s[8:11], s19 offen lds
    v_mfma_f32_16x16x32_bf16 v[116:119], v[64:67], v[36:39], v[116:119]
    s_add_u32 s18, s18, 128
    s_add_u32 s19, s19, s22
    v_mfma_f32_16x16x32_bf16 v[120:123], v[64:67], v[40:43], v[120:123]
    ds_read_b128 v[52:55], v9 offset:36864
    ds_read_b128 v[56:59], v9 offset:38912
    s_waitcnt lgkmcnt(8)
    v_mfma_f32_16x16x32_bf16 v[124:127], v[68:71], v[28:31], v[124:127]
    ds_read_b64_tr_b16 v[80:81], v11 offset:40960
    ds_read_b64_tr_b16 v[82:83], v11 offset:41984
    v_mfma_f32_16x16x32_bf16 v[128:131], v[68:71], v[32:35], v[128:131]
    ds_read_b64_tr_b16 v[84:85], v12 offset:40960
    ds_read_b64_tr_b16 v[86:87], v12 offset:41984
    v_mfma_f32_16x16x32_bf16 v[132:135], v[68:71], v[36:39], v[132:135]
    ds_read_b64_tr_b16 v[88:89], v13 offset:40960
    ds_read_b64_tr_b16 v[90:91], v13 offset:41984
    v_mfma_f32_16x16x32_bf16 v[136:139], v[68:71], v[40:43], v[136:139]
    s_waitcnt lgkmcnt(12)
    v_mfma_f32_16x16x32_bf16 v[140:143], v[72:75], v[28:31], v[140:143]
    v_mfma_f32_16x16x32_bf16 v[144:147], v[72:75], v[32:35], v[144:147]
    v_mfma_f32_16x16x32_bf16 v[148:151], v[72:75], v[36:39], v[148:151]
    v_mfma_f32_16x16x32_bf16 v[152:155], v[72:75], v[40:43], v[152:155]
    s_waitcnt lgkmcnt(9)
    v_mfma_f32_16x16x32_bf16 v[92:95], v[76:79], v[44:47], v[92:95]
    s_waitcnt lgkmcnt(8)
    v_mfma_f32_16x16x32_bf16 v[96:99], v[76:79], v[48:51], v[96:99]
    s_waitcnt lgkmcnt(0)
    s_waitcnt vmcnt(16)
    s_barrier
    v_mfma_f32_16x16x32_bf16 v[100:103], v[76:79], v[52:55], v[100:103]
    s_add_u32 m0, s21, 0x8000
    ds_read_b64_tr_b16 v[60:61], v10 offset:49152
    v_mfma_f32_16x16x32_bf16 v[104:107], v[76:79], v[56:59], v[104:107]
    buffer_load_dwordx4 v14, s[4:7], s18 offen lds
    s_add_u32 m0, s21, 0x9000
    v_mfma_f32_16x16x32_bf16 v[108:111], v[80:83], v[44:47], v[108:111]
    ds_read_b64_tr_b16 v[62:63], v10 offset:50176
    buffer_load_dwordx4 v15, s[4:7], s18 offen lds
    v_mfma_f32_16x16x32_bf16 v[112:115], v[80:83], v[48:51], v[112:115]
    s_add_u32 m0, s21, 0xa000
    ds_read_b128 v[28:31], v8 offset:49152
    v_mfma_f32_16x16x32_bf16 v[116:119], v[80:83], v[52:55], v[116:119]
    buffer_load_dwordx4 v16, s[4:7], s18 offen lds
    s_add_u32 m0, s21, 0xb000
    v_mfma_f32_16x16x32_bf16 v[120:123], v[80:83], v[56:59], v[120:123]
    ds_read_b128 v[32:35], v8 offset:51200
    buffer_load_dwordx4 v17, s[4:7], s18 offen lds
    v_mfma_f32_16x16x32_bf16 v[124:127], v[84:87], v[44:47], v[124:127]
    ds_read_b128 v[36:39], v8 offset:53248
    ds_read_b128 v[40:43], v8 offset:55296
    v_mfma_f32_16x16x32_bf16 v[128:131], v[84:87], v[48:51], v[128:131]
    ds_read_b64_tr_b16 v[64:65], v11 offset:49152
    ds_read_b64_tr_b16 v[66:67], v11 offset:50176
    v_mfma_f32_16x16x32_bf16 v[132:135], v[84:87], v[52:55], v[132:135]
    ds_read_b64_tr_b16 v[68:69], v12 offset:49152
    ds_read_b64_tr_b16 v[70:71], v12 offset:50176
    v_mfma_f32_16x16x32_bf16 v[136:139], v[84:87], v[56:59], v[136:139]
    ds_read_b64_tr_b16 v[72:73], v13 offset:49152
    ds_read_b64_tr_b16 v[74:75], v13 offset:50176
    v_mfma_f32_16x16x32_bf16 v[140:143], v[88:91], v[44:47], v[140:143]
    v_mfma_f32_16x16x32_bf16 v[144:147], v[88:91], v[48:51], v[144:147]
    v_mfma_f32_16x16x32_bf16 v[148:151], v[88:91], v[52:55], v[148:151]
    v_mfma_f32_16x16x32_bf16 v[152:155], v[88:91], v[56:59], v[152:155]
    s_waitcnt lgkmcnt(9)
    v_mfma_f32_16x16x32_bf16 v[92:95], v[60:63], v[28:31], v[92:95]
    s_add_u32 m0, s21, 0x18000
    ds_read_b64_tr_b16 v[76:77], v10 offset:57344
    s_waitcnt lgkmcnt(9)
    v_mfma_f32_16x16x32_bf16 v[96:99], v[60:63], v[32:35], v[96:99]
    buffer_load_dwordx4 v18, s[8:11], s19 offen lds
    s_add_u32 m0, s21, 0x19000
    s_waitcnt lgkmcnt(8)
    v_mfma_f32_16x16x32_bf16 v[100:103], v[60:63], v[36:39], v[100:103]
    ds_read_b64_tr_b16 v[78:79], v10 offset:58368
    buffer_load_dwordx4 v19, s[8:11], s19 offen lds
    s_waitcnt lgkmcnt(8)
    v_mfma_f32_16x16x32_bf16 v[104:107], v[60:63], v[40:43], v[104:107]
    s_add_u32 m0, s21, 0x1a000
    ds_read_b128 v[44:47], v9 offset:49152
    s_waitcnt lgkmcnt(7)
    v_mfma_f32_16x16x32_bf16 v[108:111], v[64:67], v[28:31], v[108:111]
    buffer_load_dwordx4 v20, s[8:11], s19 offen lds
    s_add_u32 m0, s21, 0x1b000
    v_mfma_f32_16x16x32_bf16 v[112:115], v[64:67], v[32:35], v[112:115]
    ds_read_b128 v[48:51], v9 offset:51200
    buffer_load_dwordx4 v21, s[8:11], s19 offen lds
    v_mfma_f32_16x16x32_bf16 v[116:119], v[64:67], v[36:39], v[116:119]
    s_add_u32 s18, s18, 128
    s_add_u32 s19, s19, s22
    v_mfma_f32_16x16x32_bf16 v[120:123], v[64:67], v[40:43], v[120:123]
    ds_read_b128 v[52:55], v9 offset:53248
    ds_read_b128 v[56:59], v9 offset:55296
    s_waitcnt lgkmcnt(8)
    v_mfma_f32_16x16x32_bf16 v[124:127], v[68:71], v[28:31], v[124:127]
    ds_read_b64_tr_b16 v[80:81], v11 offset:57344
    ds_read_b64_tr_b16 v[82:83], v11 offset:58368
    v_mfma_f32_16x16x32_bf16 v[128:131], v[68:71], v[32:35], v[128:131]
    ds_read_b64_tr_b16 v[84:85], v12 offset:57344
    ds_read_b64_tr_b16 v[86:87], v12 offset:58368
    v_mfma_f32_16x16x32_bf16 v[132:135], v[68:71], v[36:39], v[132:135]
    ds_read_b64_tr_b16 v[88:89], v13 offset:57344
    ds_read_b64_tr_b16 v[90:91], v13 offset:58368
    v_mfma_f32_16x16x32_bf16 v[136:139], v[68:71], v[40:43], v[136:139]
    s_waitcnt lgkmcnt(12)
    v_mfma_f32_16x16x32_bf16 v[140:143], v[72:75], v[28:31], v[140:143]
    v_mfma_f32_16x16x32_bf16 v[144:147], v[72:75], v[32:35], v[144:147]
    v_mfma_f32_16x16x32_bf16 v[148:151], v[72:75], v[36:39], v[148:151]
    v_mfma_f32_16x16x32_bf16 v[152:155], v[72:75], v[40:43], v[152:155]
    s_waitcnt lgkmcnt(9)
    v_mfma_f32_16x16x32_bf16 v[92:95], v[76:79], v[44:47], v[92:95]
    s_waitcnt lgkmcnt(8)
    v_mfma_f32_16x16x32_bf16 v[96:99], v[76:79], v[48:51], v[96:99]
    s_waitcnt lgkmcnt(0)
    s_waitcnt vmcnt(16)
    s_barrier
    v_mfma_f32_16x16x32_bf16 v[100:103], v[76:79], v[52:55], v[100:103]
    s_add_u32 m0, s21, 0xc000
    ds_read_b64_tr_b16 v[60:61], v10 offset:0
    v_mfma_f32_16x16x32_bf16 v[104:107], v[76:79], v[56:59], v[104:107]
    buffer_load_dwordx4 v14, s[4:7], s18 offen lds
    s_add_u32 m0, s21, 0xd000
    v_mfma_f32_16x16x32_bf16 v[108:111], v[80:83], v[44:47], v[108:111]
    ds_read_b64_tr_b16 v[62:63], v10 offset:1024
    buffer_load_dwordx4 v15, s[4:7], s18 offen lds
    v_mfma_f32_16x16x32_bf16 v[112:115], v[80:83], v[48:51], v[112:115]
    s_add_u32 m0, s21, 0xe000
    ds_read_b128 v[28:31], v8 offset:0
    v_mfma_f32_16x16x32_bf16 v[116:119], v[80:83], v[52:55], v[116:119]
    buffer_load_dwordx4 v16, s[4:7], s18 offen lds
    s_add_u32 m0, s21, 0xf000
    v_mfma_f32_16x16x32_bf16 v[120:123], v[80:83], v[56:59], v[120:123]
    ds_read_b128 v[32:35], v8 offset:2048
    buffer_load_dwordx4 v17, s[4:7], s18 offen lds
    v_mfma_f32_16x16x32_bf16 v[124:127], v[84:87], v[44:47], v[124:127]
    ds_read_b128 v[36:39], v8 offset:4096
    ds_read_b128 v[40:43], v8 offset:6144
    v_mfma_f32_16x16x32_bf16 v[128:131], v[84:87], v[48:51], v[128:131]
    ds_read_b64_tr_b16 v[64:65], v11 offset:0
    ds_read_b64_tr_b16 v[66:67], v11 offset:1024
    v_mfma_f32_16x16x32_bf16 v[132:135], v[84:87], v[52:55], v[132:135]
    ds_read_b64_tr_b16 v[68:69], v12 offset:0
    ds_read_b64_tr_b16 v[70:71], v12 offset:1024
    v_mfma_f32_16x16x32_bf16 v[136:139], v[84:87], v[56:59], v[136:139]
    ds_read_b64_tr_b16 v[72:73], v13 offset:0
    ds_read_b64_tr_b16 v[74:75], v13 offset:1024
    v_mfma_f32_16x16x32_bf16 v[140:143], v[88:91], v[44:47], v[140:143]
    v_mfma_f32_16x16x32_bf16 v[144:147], v[88:91], v[48:51], v[144:147]
    v_mfma_f32_16x16x32_bf16 v[148:151], v[88:91], v[52:55], v[148:151]
    v_mfma_f32_16x16x32_bf16 v[152:155], v[88:91], v[56:59], v[152:155]
    s_sub_u32 s20, s20, 1
    s_cmp_eq_u32 s20, 0
    s_cbranch_scc1 L_g2_loop_skip
L_g2_loop:
    s_waitcnt lgkmcnt(9)
    v_mfma_f32_16x16x32_bf16 v[92:95], v[60:63], v[28:31], v[92:95]
    s_add_u32 m0, s21, 0x1c000
    ds_read_b64_tr_b16 v[76:77], v10 offset:8192
    s_waitcnt lgkmcnt(9)
    v_mfma_f32_16x16x32_bf16 v[96:99], v[60:63], v[32:35], v[96:99]
    buffer_load_dwordx4 v18, s[8:11], s19 offen lds
    s_add_u32 m0, s21, 0x1d000
    s_waitcnt lgkmcnt(8)
    v_mfma_f32_16x16x32_bf16 v[100:103], v[60:63], v[36:39], v[100:103]
    ds_read_b64_tr_b16 v[78:79], v10 offset:9216
    buffer_load_dwordx4 v19, s[8:11], s19 offen lds
    s_waitcnt lgkmcnt(8)
    v_mfma_f32_16x16x32_bf16 v[104:107], v[60:63], v[40:43], v[104:107]
    s_add_u32 m0, s21, 0x1e000
    ds_read_b128 v[44:47], v9 offset:0
    s_waitcnt lgkmcnt(7)
    v_mfma_f32_16x16x32_bf16 v[108:111], v[64:67], v[28:31], v[108:111]
    buffer_load_dwordx4 v20, s[8:11], s19 offen lds
    s_add_u32 m0, s21, 0x1f000
    v_mfma_f32_16x16x32_bf16 v[112:115], v[64:67], v[32:35], v[112:115]
    ds_read_b128 v[48:51], v9 offset:2048
    buffer_load_dwordx4 v21, s[8:11], s19 offen lds
    v_mfma_f32_16x16x32_bf16 v[116:119], v[64:67], v[36:39], v[116:119]
    s_add_u32 s18, s18, 128
    s_add_u32 s19, s19, s22
    v_mfma_f32_16x16x32_bf16 v[120:123], v[64:67], v[40:43], v[120:123]
    ds_read_b128 v[52:55], v9 offset:4096
    ds_read_b128 v[56:59], v9 offset:6144
    s_waitcnt lgkmcnt(8)
    v_mfma_f32_16x16x32_bf16 v[124:127], v[68:71], v[28:31], v[124:127]
    ds_read_b64_tr_b16 v[80:81], v11 offset:8192
    ds_read_b64_tr_b16 v[82:83], v11 offset:9216
    v_mfma_f32_16x16x32_bf16 v[128:131], v[68:71], v[32:35], v[128:131]
    ds_read_b64_tr_b16 v[84:85], v12 offset:8192
    ds_read_b64_tr_b16 v[86:87], v12 offset:9216
    v_mfma_f32_16x16x32_bf16 v[132:135], v[68:71], v[36:39], v[132:135]
    ds_read_b64_tr_b16 v[88:89], v13 offset:8192
    ds_read_b64_tr_b16 v[90:91], v13 offset:9216
    v_mfma_f32_16x16x32_bf16 v[136:139], v[68:71], v[40:43], v[136:139]
    s_waitcnt lgkmcnt(12)
    v_mfma_f32_16x16x32_bf16 v[140:143], v[72:75], v[28:31], v[140:143]
    v_mfma_f32_16x16x32_bf16 v[144:147], v[72:75], v[32:35], v[144:147]
    v_mfma_f32_16x16x32_bf16 v[148:151], v[72:75], v[36:39], v[148:151]
    v_mfma_f32_16x16x32_bf16 v[152:155], v[72:75], v[40:43], v[152:155]
    s_waitcnt lgkmcnt(9)
    v_mfma_f32_16x16x32_bf16 v[92:95], v[76:79], v[44:47], v[92:95]
    s_waitcnt lgkmcnt(8)
    v_mfma_f32_16x16x32_bf16 v[96:99], v[76:79], v[48:51], v[96:99]
    s_waitcnt lgkmcnt(0)
    s_waitcnt vmcnt(16)
    s_barrier
    v_mfma_f32_16x16x32_bf16 v[100:103], v[76:79], v[52:55], v[100:103]
    s_add_u32 m0, s21, 0x0
    ds_read_b64_tr_b16 v[60:61], v10 offset:16384
    v_mfma_f32_16x16x32_bf16 v[104:107], v[76:79], v[56:59], v[104:107]
    buffer_load_dwordx4 v14, s[4:7], s18 offen lds
    s_add_u32 m0, s21, 0x1000
    v_mfma_f32_16x16x32_bf16 v[108:111], v[80:83], v[44:47], v[108:111]
    ds_read_b64_tr_b16 v[62:63], v10 offset:17408
    buffer_load_dwordx4 v15, s[4:7], s18 offen lds
    v_mfma_f32_16x16x32_bf16 v[112:115], v[80:83], v[48:51], v[112:115]
    s_add_u32 m0, s21, 0x2000
    ds_read_b128 v[28:31], v8 offset:16384
    v_mfma_f32_16x16x32_bf16 v[116:119], v[80:83], v[52:55], v[116:119]
    buffer_load_dwordx4 v16, s[4:7], s18 offen lds
    s_add_u32 m0, s21, 0x3000
    v_mfma_f32_16x16x32_bf16 v[120:123], v[80:83], v[56:59], v[120:123]
    ds_read_b128 v[32:35], v8 offset:18432
    buffer_load_dwordx4 v17, s[4:7], s18 offen lds
    v_mfma_f32_16x16x32_bf16 v[124:127], v[84:87], v[44:47], v[124:127]
    ds_read_b128 v[36:39], v8 offset:20480
    ds_read_b128 v[40:43], v8 offset:22528
    v_mfma_f32_16x16x32_bf16 v[128:131], v[84:87], v[48:51], v[128:131]
    ds_read_b64_tr_b16 v[64:65], v11 offset:16384
    ds_read_b64_tr_b16 v[66:67], v11 offset:17408
    v_mfma_f32_16x16x32_bf16 v[132:135], v[84:87], v[52:55], v[132:135]
    ds_read_b64_tr_b16 v[68:69], v12 offset:16384
    ds_read_b64_tr_b16 v[70:71], v12 offset:17408
    v_mfma_f32_16x16x32_bf16 v[136:139], v[84:87], v[56:59], v[136:139]
    ds_read_b64_tr_b16 v[72:73], v13 offset:16384
    ds_read_b64_tr_b16 v[74:75], v13 offset:17408
    v_mfma_f32_16x16x32_bf16 v[140:143], v[88:91], v[44:47], v[140:143]
    v_mfma_f32_16x16x32_bf16 v[144:147], v[88:91], v[48:51], v[144:147]
    v_mfma_f32_16x16x32_bf16 v[148:151], v[88:91], v[52:55], v[148:151]
    v_mfma_f32_16x16x32_bf16 v[152:155], v[88:91], v[56:59], v[152:155]
    s_waitcnt lgkmcnt(9)
    v_mfma_f32_16x16x32_bf16 v[92:95], v[60:63], v[28:31], v[92:95]
    s_add_u32 m0, s21, 0x10000
    ds_read_b64_tr_b16 v[76:77], v10 offset:24576
    s_waitcnt lgkmcnt(9)
    v_mfma_f32_16x16x32_bf16 v[96:99], v[60:63], v[32:35], v[96:99]
    buffer_load_dwordx4 v18, s[8:11], s19 offen lds
    s_add_u32 m0, s21, 0x11000
    s_waitcnt lgkmcnt(8)
    v_mfma_f32_16x16x32_bf16 v[100:103], v[60:63], v[36:39], v[100:103]
    ds_read_b64_tr_b16 v[78:79], v10 offset:25600
    buffer_load_dwordx4 v19, s[8:11], s19 offen lds
    s_waitcnt lgkmcnt(8)
    v_mfma_f32_16x16x32_bf16 v[104:107], v[60:63], v[40:43], v[104:107]
    s_add_u32 m0, s21, 0x12000
    ds_read_b128 v[44:47], v9 offset:16384
    s_waitcnt lgkmcnt(7)
    v_mfma_f32_16x16x32_bf16 v[108:111], v[64:67], v[28:31], v[108:111]
    buffer_load_dwordx4 v20, s[8:11], s19 offen lds
    s_add_u32 m0, s21, 0x13000
    v_mfma_f32_16x16x32_bf16 v[112:115], v[64:67], v[32:35], v[112:115]
    ds_read_b128 v[48:51], v9 offset:18432
    buffer_load_dwordx4 v21, s[8:11], s19 offen lds
    v_mfma_f32_16x16x32_bf16 v[116:119], v[64:67], v[36:39], v[116:119]
    s_add_u32 s18, s18, 128
    s_add_u32 s19, s19, s22
    v_mfma_f32_16x16x32_bf16 v[120:123], v[64:67], v[40:43], v[120:123]
    ds_read_b128 v[52:55], v9 offset:20480
    ds_read_b128 v[56:59], v9 offset:22528
    s_waitcnt lgkmcnt(8)
    v_mfma_f32_16x16x32_bf16 v[124:127], v[68:71], v[28:31], v[124:127]
    ds_read_b64_tr_b16 v[80:81], v11 offset:24576
    ds_read_b64_tr_b16 v[82:83], v11 offset:25600
    v_mfma_f32_16x16x32_bf16 v[128:131], v[68:71], v[32:35], v[128:131]
    ds_read_b64_tr_b16 v[84:85], v12 offset:24576
    ds_read_b64_tr_b16 v[86:87], v12 offset:25600
    v_mfma_f32_16x16x32_bf16 v[132:135], v[68:71], v[36:39], v[132:135]
    ds_read_b64_tr_b16 v[88:89], v13 offset:24576
    ds_read_b64_tr_b16 v[90:91], v13 offset:25600
    v_mfma_f32_16x16x32_bf16 v[136:139], v[68:71], v[40:43], v[136:139]
    s_waitcnt lgkmcnt(12)
    v_mfma_f32_16x16x32_bf16 v[140:143], v[72:75], v[28:31], v[140:143]
    v_mfma_f32_16x16x32_bf16 v[144:147], v[72:75], v[32:35], v[144:147]
    v_mfma_f32_16x16x32_bf16 v[148:151], v[72:75], v[36:39], v[148:151]
    v_mfma_f32_16x16x32_bf16 v[152:155], v[72:75], v[40:43], v[152:155]
    s_waitcnt lgkmcnt(9)
    v_mfma_f32_16x16x32_bf16 v[92:95], v[76:79], v[44:47], v[92:95]
    s_waitcnt lgkmcnt(8)
    v_mfma_f32_16x16x32_bf16 v[96:99], v[76:79], v[48:51], v[96:99]
    s_waitcnt lgkmcnt(0)
    s_waitcnt vmcnt(16)
    s_barrier
    v_mfma_f32_16x16x32_bf16 v[100:103], v[76:79], v[52:55], v[100:103]
    s_add_u32 m0, s21, 0x4000
    ds_read_b64_tr_b16 v[60:61], v10 offset:32768
    v_mfma_f32_16x16x32_bf16 v[104:107], v[76:79], v[56:59], v[104:107]
    buffer_load_dwordx4 v14, s[4:7], s18 offen lds
    s_add_u32 m0, s21, 0x5000
    v_mfma_f32_16x16x32_bf16 v[108:111], v[80:83], v[44:47], v[108:111]
    ds_read_b64_tr_b16 v[62:63], v10 offset:33792
    buffer_load_dwordx4 v15, s[4:7], s18 offen lds
    v_mfma_f32_16x16x32_bf16 v[112:115], v[80:83], v[48:51], v[112:115]
    s_add_u32 m0, s21, 0x6000
    ds_read_b128 v[28:31], v8 offset:32768
    v_mfma_f32_16x16x32_bf16 v[116:119], v[80:83], v[52:55], v[116:119]
    buffer_load_dwordx4 v16, s[4:7], s18 offen lds
    s_add_u32 m0, s21, 0x7000
    v_mfma_f32_16x16x32_bf16 v[120:123], v[80:83], v[56:59], v[120:123]
    ds_read_b128 v[32:35], v8 offset:34816
    buffer_load_dwordx4 v17, s[4:7], s18 offen lds
    v_mfma_f32_16x16x32_bf16 v[124:127], v[84:87], v[44:47], v[124:127]
    ds_read_b128 v[36:39], v8 offset:36864
    ds_read_b128 v[40:43], v8 offset:38912
    v_mfma_f32_16x16x32_bf16 v[128:131], v[84:87], v[48:51], v[128:131]
    ds_read_b64_tr_b16 v[64:65], v11 offset:32768
    ds_read_b64_tr_b16 v[66:67], v11 offset:33792
    v_mfma_f32_16x16x32_bf16 v[132:135], v[84:87], v[52:55], v[132:135]
    ds_read_b64_tr_b16 v[68:69], v12 offset:32768
    ds_read_b64_tr_b16 v[70:71], v12 offset:33792
    v_mfma_f32_16x16x32_bf16 v[136:139], v[84:87], v[56:59], v[136:139]
    ds_read_b64_tr_b16 v[72:73], v13 offset:32768
    ds_read_b64_tr_b16 v[74:75], v13 offset:33792
    v_mfma_f32_16x16x32_bf16 v[140:143], v[88:91], v[44:47], v[140:143]
    v_mfma_f32_16x16x32_bf16 v[144:147], v[88:91], v[48:51], v[144:147]
    v_mfma_f32_16x16x32_bf16 v[148:151], v[88:91], v[52:55], v[148:151]
    v_mfma_f32_16x16x32_bf16 v[152:155], v[88:91], v[56:59], v[152:155]
    s_waitcnt lgkmcnt(9)
    v_mfma_f32_16x16x32_bf16 v[92:95], v[60:63], v[28:31], v[92:95]
    s_add_u32 m0, s21, 0x14000
    ds_read_b64_tr_b16 v[76:77], v10 offset:40960
    s_waitcnt lgkmcnt(9)
    v_mfma_f32_16x16x32_bf16 v[96:99], v[60:63], v[32:35], v[96:99]
    buffer_load_dwordx4 v18, s[8:11], s19 offen lds
    s_add_u32 m0, s21, 0x15000
    s_waitcnt lgkmcnt(8)
    v_mfma_f32_16x16x32_bf16 v[100:103], v[60:63], v[36:39], v[100:103]
    ds_read_b64_tr_b16 v[78:79], v10 offset:41984
    buffer_load_dwordx4 v19, s[8:11], s19 offen lds
    s_waitcnt lgkmcnt(8)
    v_mfma_f32_16x16x32_bf16 v[104:107], v[60:63], v[40:43], v[104:107]
    s_add_u32 m0, s21, 0x16000
    ds_read_b128 v[44:47], v9 offset:32768
    s_waitcnt lgkmcnt(7)
    v_mfma_f32_16x16x32_bf16 v[108:111], v[64:67], v[28:31], v[108:111]
    buffer_load_dwordx4 v20, s[8:11], s19 offen lds
    s_add_u32 m0, s21, 0x17000
    v_mfma_f32_16x16x32_bf16 v[112:115], v[64:67], v[32:35], v[112:115]
    ds_read_b128 v[48:51], v9 offset:34816
    buffer_load_dwordx4 v21, s[8:11], s19 offen lds
    v_mfma_f32_16x16x32_bf16 v[116:119], v[64:67], v[36:39], v[116:119]
    s_add_u32 s18, s18, 128
    s_add_u32 s19, s19, s22
    v_mfma_f32_16x16x32_bf16 v[120:123], v[64:67], v[40:43], v[120:123]
    ds_read_b128 v[52:55], v9 offset:36864
    ds_read_b128 v[56:59], v9 offset:38912
    s_waitcnt lgkmcnt(8)
    v_mfma_f32_16x16x32_bf16 v[124:127], v[68:71], v[28:31], v[124:127]
    ds_read_b64_tr_b16 v[80:81], v11 offset:40960
    ds_read_b64_tr_b16 v[82:83], v11 offset:41984
    v_mfma_f32_16x16x32_bf16 v[128:131], v[68:71], v[32:35], v[128:131]
    ds_read_b64_tr_b16 v[84:85], v12 offset:40960
    ds_read_b64_tr_b16 v[86:87], v12 offset:41984
    v_mfma_f32_16x16x32_bf16 v[132:135], v[68:71], v[36:39], v[132:135]
    ds_read_b64_tr_b16 v[88:89], v13 offset:40960
    ds_read_b64_tr_b16 v[90:91], v13 offset:41984
    v_mfma_f32_16x16x32_bf16 v[136:139], v[68:71], v[40:43], v[136:139]
    s_waitcnt lgkmcnt(12)
    v_mfma_f32_16x16x32_bf16 v[140:143], v[72:75], v[28:31], v[140:143]
    v_mfma_f32_16x16x32_bf16 v[144:147], v[72:75], v[32:35], v[144:147]
    v_mfma_f32_16x16x32_bf16 v[148:151], v[72:75], v[36:39], v[148:151]
    v_mfma_f32_16x16x32_bf16 v[152:155], v[72:75], v[40:43], v[152:155]
    s_waitcnt lgkmcnt(9)
    v_mfma_f32_16x16x32_bf16 v[92:95], v[76:79], v[44:47], v[92:95]
    s_waitcnt lgkmcnt(8)
    v_mfma_f32_16x16x32_bf16 v[96:99], v[76:79], v[48:51], v[96:99]
    s_waitcnt lgkmcnt(0)
    s_waitcnt vmcnt(16)
    s_barrier
    v_mfma_f32_16x16x32_bf16 v[100:103], v[76:79], v[52:55], v[100:103]
    s_add_u32 m0, s21, 0x8000
    ds_read_b64_tr_b16 v[60:61], v10 offset:49152
    v_mfma_f32_16x16x32_bf16 v[104:107], v[76:79], v[56:59], v[104:107]
    buffer_load_dwordx4 v14, s[4:7], s18 offen lds
    s_add_u32 m0, s21, 0x9000
    v_mfma_f32_16x16x32_bf16 v[108:111], v[80:83], v[44:47], v[108:111]
    ds_read_b64_tr_b16 v[62:63], v10 offset:50176
    buffer_load_dwordx4 v15, s[4:7], s18 offen lds
    v_mfma_f32_16x16x32_bf16 v[112:115], v[80:83], v[48:51], v[112:115]
    s_add_u32 m0, s21, 0xa000
    ds_read_b128 v[28:31], v8 offset:49152
    v_mfma_f32_16x16x32_bf16 v[116:119], v[80:83], v[52:55], v[116:119]
    buffer_load_dwordx4 v16, s[4:7], s18 offen lds
    s_add_u32 m0, s21, 0xb000
    v_mfma_f32_16x16x32_bf16 v[120:123], v[80:83], v[56:59], v[120:123]
    ds_read_b128 v[32:35], v8 offset:51200
    buffer_load_dwordx4 v17, s[4:7], s18 offen lds
    v_mfma_f32_16x16x32_bf16 v[124:127], v[84:87], v[44:47], v[124:127]
    ds_read_b128 v[36:39], v8 offset:53248
    ds_read_b128 v[40:43], v8 offset:55296
    v_mfma_f32_16x16x32_bf16 v[128:131], v[84:87], v[48:51], v[128:131]
    ds_read_b64_tr_b16 v[64:65], v11 offset:49152
    ds_read_b64_tr_b16 v[66:67], v11 offset:50176
    v_mfma_f32_16x16x32_bf16 v[132:135], v[84:87], v[52:55], v[132:135]
    ds_read_b64_tr_b16 v[68:69], v12 offset:49152
    ds_read_b64_tr_b16 v[70:71], v12 offset:50176
    v_mfma_f32_16x16x32_bf16 v[136:139], v[84:87], v[56:59], v[136:139]
    ds_read_b64_tr_b16 v[72:73], v13 offset:49152
    ds_read_b64_tr_b16 v[74:75], v13 offset:50176
    v_mfma_f32_16x16x32_bf16 v[140:143], v[88:91], v[44:47], v[140:143]
    v_mfma_f32_16x16x32_bf16 v[144:147], v[88:91], v[48:51], v[144:147]
    v_mfma_f32_16x16x32_bf16 v[148:151], v[88:91], v[52:55], v[148:151]
    v_mfma_f32_16x16x32_bf16 v[152:155], v[88:91], v[56:59], v[152:155]
    s_waitcnt lgkmcnt(9)
    v_mfma_f32_16x16x32_bf16 v[92:95], v[60:63], v[28:31], v[92:95]
    s_add_u32 m0, s21, 0x18000
    ds_read_b64_tr_b16 v[76:77], v10 offset:57344
    s_waitcnt lgkmcnt(9)
    v_mfma_f32_16x16x32_bf16 v[96:99], v[60:63], v[32:35], v[96:99]
    buffer_load_dwordx4 v18, s[8:11], s19 offen lds
    s_add_u32 m0, s21, 0x19000
    s_waitcnt lgkmcnt(8)
    v_mfma_f32_16x16x32_bf16 v[100:103], v[60:63], v[36:39], v[100:103]
    ds_read_b64_tr_b16 v[78:79], v10 offset:58368
    buffer_load_dwordx4 v19, s[8:11], s19 offen lds
    s_waitcnt lgkmcnt(8)
    v_mfma_f32_16x16x32_bf16 v[104:107], v[60:63], v[40:43], v[104:107]
    s_add_u32 m0, s21, 0x1a000
    ds_read_b128 v[44:47], v9 offset:49152
    s_waitcnt lgkmcnt(7)
    v_mfma_f32_16x16x32_bf16 v[108:111], v[64:67], v[28:31], v[108:111]
    buffer_load_dwordx4 v20, s[8:11], s19 offen lds
    s_add_u32 m0, s21, 0x1b000
    v_mfma_f32_16x16x32_bf16 v[112:115], v[64:67], v[32:35], v[112:115]
    ds_read_b128 v[48:51], v9 offset:51200
    buffer_load_dwordx4 v21, s[8:11], s19 offen lds
    v_mfma_f32_16x16x32_bf16 v[116:119], v[64:67], v[36:39], v[116:119]
    s_add_u32 s18, s18, 128
    s_add_u32 s19, s19, s22
    v_mfma_f32_16x16x32_bf16 v[120:123], v[64:67], v[40:43], v[120:123]
    ds_read_b128 v[52:55], v9 offset:53248
    ds_read_b128 v[56:59], v9 offset:55296
    s_waitcnt lgkmcnt(8)
    v_mfma_f32_16x16x32_bf16 v[124:127], v[68:71], v[28:31], v[124:127]
    ds_read_b64_tr_b16 v[80:81], v11 offset:57344
    ds_read_b64_tr_b16 v[82:83], v11 offset:58368
    v_mfma_f32_16x16x32_bf16 v[128:131], v[68:71], v[32:35], v[128:131]
    ds_read_b64_tr_b16 v[84:85], v12 offset:57344
    ds_read_b64_tr_b16 v[86:87], v12 offset:58368
    v_mfma_f32_16x16x32_bf16 v[132:135], v[68:71], v[36:39], v[132:135]
    ds_read_b64_tr_b16 v[88:89], v13 offset:57344
    ds_read_b64_tr_b16 v[90:91], v13 offset:58368
    v_mfma_f32_16x16x32_bf16 v[136:139], v[68:71], v[40:43], v[136:139]
    s_waitcnt lgkmcnt(12)
    v_mfma_f32_16x16x32_bf16 v[140:143], v[72:75], v[28:31], v[140:143]
    v_mfma_f32_16x16x32_bf16 v[144:147], v[72:75], v[32:35], v[144:147]
    v_mfma_f32_16x16x32_bf16 v[148:151], v[72:75], v[36:39], v[148:151]
    v_mfma_f32_16x16x32_bf16 v[152:155], v[72:75], v[40:43], v[152:155]
    s_waitcnt lgkmcnt(9)
    v_mfma_f32_16x16x32_bf16 v[92:95], v[76:79], v[44:47], v[92:95]
    s_waitcnt lgkmcnt(8)
    v_mfma_f32_16x16x32_bf16 v[96:99], v[76:79], v[48:51], v[96:99]
    s_waitcnt lgkmcnt(0)
    s_waitcnt vmcnt(16)
    s_barrier
    v_mfma_f32_16x16x32_bf16 v[100:103], v[76:79], v[52:55], v[100:103]
    s_add_u32 m0, s21, 0xc000
    ds_read_b64_tr_b16 v[60:61], v10 offset:0
    v_mfma_f32_16x16x32_bf16 v[104:107], v[76:79], v[56:59], v[104:107]
    buffer_load_dwordx4 v14, s[4:7], s18 offen lds
    s_add_u32 m0, s21, 0xd000
    v_mfma_f32_16x16x32_bf16 v[108:111], v[80:83], v[44:47], v[108:111]
    ds_read_b64_tr_b16 v[62:63], v10 offset:1024
    buffer_load_dwordx4 v15, s[4:7], s18 offen lds
    v_mfma_f32_16x16x32_bf16 v[112:115], v[80:83], v[48:51], v[112:115]
    s_add_u32 m0, s21, 0xe000
    ds_read_b128 v[28:31], v8 offset:0
    v_mfma_f32_16x16x32_bf16 v[116:119], v[80:83], v[52:55], v[116:119]
    buffer_load_dwordx4 v16, s[4:7], s18 offen lds
    s_add_u32 m0, s21, 0xf000
    v_mfma_f32_16x16x32_bf16 v[120:123], v[80:83], v[56:59], v[120:123]
    ds_read_b128 v[32:35], v8 offset:2048
    buffer_load_dwordx4 v17, s[4:7], s18 offen lds
    v_mfma_f32_16x16x32_bf16 v[124:127], v[84:87], v[44:47], v[124:127]
    ds_read_b128 v[36:39], v8 offset:4096
    ds_read_b128 v[40:43], v8 offset:6144
    v_mfma_f32_16x16x32_bf16 v[128:131], v[84:87], v[48:51], v[128:131]
    ds_read_b64_tr_b16 v[64:65], v11 offset:0
    ds_read_b64_tr_b16 v[66:67], v11 offset:1024
    v_mfma_f32_16x16x32_bf16 v[132:135], v[84:87], v[52:55], v[132:135]
    ds_read_b64_tr_b16 v[68:69], v12 offset:0
    ds_read_b64_tr_b16 v[70:71], v12 offset:1024
    v_mfma_f32_16x16x32_bf16 v[136:139], v[84:87], v[56:59], v[136:139]
    ds_read_b64_tr_b16 v[72:73], v13 offset:0
    ds_read_b64_tr_b16 v[74:75], v13 offset:1024
    v_mfma_f32_16x16x32_bf16 v[140:143], v[88:91], v[44:47], v[140:143]
    v_mfma_f32_16x16x32_bf16 v[144:147], v[88:91], v[48:51], v[144:147]
    v_mfma_f32_16x16x32_bf16 v[148:151], v[88:91], v[52:55], v[148:151]
    v_mfma_f32_16x16x32_bf16 v[152:155], v[88:91], v[56:59], v[152:155]
    s_sub_u32 s20, s20, 1
    s_cmp_lg_u32 s20, 0
    s_cbranch_scc1 L_g2_loop
L_g2_loop_skip:
    s_waitcnt lgkmcnt(9)
    v_mfma_f32_16x16x32_bf16 v[92:95], v[60:63], v[28:31], v[92:95]
    s_add_u32 m0, s21, 0x1c000
    ds_read_b64_tr_b16 v[76:77], v10 offset:8192
    s_waitcnt lgkmcnt(9)
    v_mfma_f32_16x16x32_bf16 v[96:99], v[60:63], v[32:35], v[96:99]
    buffer_load_dwordx4 v18, s[8:11], s19 offen lds
    s_add_u32 m0, s21, 0x1d000
    s_waitcnt lgkmcnt(8)
    v_mfma_f32_16x16x32_bf16 v[100:103], v[60:63], v[36:39], v[100:103]
    ds_read_b64_tr_b16 v[78:79], v10 offset:9216
    buffer_load_dwordx4 v19, s[8:11], s19 offen lds
    s_waitcnt lgkmcnt(8)
    v_mfma_f32_16x16x32_bf16 v[104:107], v[60:63], v[40:43], v[104:107]
    s_add_u32 m0, s21, 0x1e000
    ds_read_b128 v[44:47], v9 offset:0
    s_waitcnt lgkmcnt(7)
    v_mfma_f32_16x16x32_bf16 v[108:111], v[64:67], v[28:31], v[108:111]
    buffer_load_dwordx4 v20, s[8:11], s19 offen lds
    s_add_u32 m0, s21, 0x1f000
    v_mfma_f32_16x16x32_bf16 v[112:115], v[64:67], v[32:35], v[112:115]
    ds_read_b128 v[48:51], v9 offset:2048
    buffer_load_dwordx4 v21, s[8:11], s19 offen lds
    v_mfma_f32_16x16x32_bf16 v[116:119], v[64:67], v[36:39], v[116:119]
    s_add_u32 s18, s18, 128
    s_add_u32 s19, s19, s22
    v_mfma_f32_16x16x32_bf16 v[120:123], v[64:67], v[40:43], v[120:123]
    ds_read_b128 v[52:55], v9 offset:4096
    ds_read_b128 v[56:59], v9 offset:6144
    s_waitcnt lgkmcnt(8)
    v_mfma_f32_16x16x32_bf16 v[124:127], v[68:71], v[28:31], v[124:127]
    ds_read_b64_tr_b16 v[80:81], v11 offset:8192
    ds_read_b64_tr_b16 v[82:83], v11 offset:9216
    v_mfma_f32_16x16x32_bf16 v[128:131], v[68:71], v[32:35], v[128:131]
    ds_read_b64_tr_b16 v[84:85], v12 offset:8192
    ds_read_b64_tr_b16 v[86:87], v12 offset:9216
    v_mfma_f32_16x16x32_bf16 v[132:135], v[68:71], v[36:39], v[132:135]
    ds_read_b64_tr_b16 v[88:89], v13 offset:8192
    ds_read_b64_tr_b16 v[90:91], v13 offset:9216
    v_mfma_f32_16x16x32_bf16 v[136:139], v[68:71], v[40:43], v[136:139]
    s_waitcnt lgkmcnt(12)
    v_mfma_f32_16x16x32_bf16 v[140:143], v[72:75], v[28:31], v[140:143]
    v_mfma_f32_16x16x32_bf16 v[144:147], v[72:75], v[32:35], v[144:147]
    v_mfma_f32_16x16x32_bf16 v[148:151], v[72:75], v[36:39], v[148:151]
    v_mfma_f32_16x16x32_bf16 v[152:155], v[72:75], v[40:43], v[152:155]
    s_waitcnt lgkmcnt(9)
    v_mfma_f32_16x16x32_bf16 v[92:95], v[76:79], v[44:47], v[92:95]
    s_waitcnt lgkmcnt(8)
    v_mfma_f32_16x16x32_bf16 v[96:99], v[76:79], v[48:51], v[96:99]
    s_waitcnt lgkmcnt(0)
    s_waitcnt vmcnt(16)
    s_barrier
    v_mfma_f32_16x16x32_bf16 v[100:103], v[76:79], v[52:55], v[100:103]
    ds_read_b64_tr_b16 v[60:61], v10 offset:16384
    ds_read_b64_tr_b16 v[62:63], v10 offset:17408
    v_mfma_f32_16x16x32_bf16 v[104:107], v[76:79], v[56:59], v[104:107]
    ds_read_b128 v[28:31], v8 offset:16384
    ds_read_b128 v[32:35], v8 offset:18432
    v_mfma_f32_16x16x32_bf16 v[108:111], v[80:83], v[44:47], v[108:111]
    ds_read_b128 v[36:39], v8 offset:20480
    ds_read_b128 v[40:43], v8 offset:22528
    v_mfma_f32_16x16x32_bf16 v[112:115], v[80:83], v[48:51], v[112:115]
    ds_read_b64_tr_b16 v[64:65], v11 offset:16384
    ds_read_b64_tr_b16 v[66:67], v11 offset:17408
    v_mfma_f32_16x16x32_bf16 v[116:119], v[80:83], v[52:55], v[116:119]
    ds_read_b64_tr_b16 v[68:69], v12 offset:16384
    ds_read_b64_tr_b16 v[70:71], v12 offset:17408
    v_mfma_f32_16x16x32_bf16 v[120:123], v[80:83], v[56:59], v[120:123]
    ds_read_b64_tr_b16 v[72:73], v13 offset:16384
    ds_read_b64_tr_b16 v[74:75], v13 offset:17408
    v_mfma_f32_16x16x32_bf16 v[124:127], v[84:87], v[44:47], v[124:127]
    v_mfma_f32_16x16x32_bf16 v[128:131], v[84:87], v[48:51], v[128:131]
    v_mfma_f32_16x16x32_bf16 v[132:135], v[84:87], v[52:55], v[132:135]
    v_mfma_f32_16x16x32_bf16 v[136:139], v[84:87], v[56:59], v[136:139]
    v_mfma_f32_16x16x32_bf16 v[140:143], v[88:91], v[44:47], v[140:143]
    v_mfma_f32_16x16x32_bf16 v[144:147], v[88:91], v[48:51], v[144:147]
    v_mfma_f32_16x16x32_bf16 v[148:151], v[88:91], v[52:55], v[148:151]
    v_mfma_f32_16x16x32_bf16 v[152:155], v[88:91], v[56:59], v[152:155]
    s_waitcnt lgkmcnt(9)
    v_mfma_f32_16x16x32_bf16 v[92:95], v[60:63], v[28:31], v[92:95]
    ds_read_b64_tr_b16 v[76:77], v10 offset:24576
    ds_read_b64_tr_b16 v[78:79], v10 offset:25600
    s_waitcnt lgkmcnt(10)
    v_mfma_f32_16x16x32_bf16 v[96:99], v[60:63], v[32:35], v[96:99]
    ds_read_b128 v[44:47], v9 offset:16384
    ds_read_b128 v[48:51], v9 offset:18432
    s_waitcnt lgkmcnt(11)
    v_mfma_f32_16x16x32_bf16 v[100:103], v[60:63], v[36:39], v[100:103]
    ds_read_b128 v[52:55], v9 offset:20480
    ds_read_b128 v[56:59], v9 offset:22528
    s_waitcnt lgkmcnt(12)
    v_mfma_f32_16x16x32_bf16 v[104:107], v[60:63], v[40:43], v[104:107]
    ds_read_b64_tr_b16 v[80:81], v11 offset:24576
    ds_read_b64_tr_b16 v[82:83], v11 offset:25600
    s_waitcnt lgkmcnt(12)
    v_mfma_f32_16x16x32_bf16 v[108:111], v[64:67], v[28:31], v[108:111]
    ds_read_b64_tr_b16 v[84:85], v12 offset:24576
    ds_read_b64_tr_b16 v[86:87], v12 offset:25600
    v_mfma_f32_16x16x32_bf16 v[112:115], v[64:67], v[32:35], v[112:115]
    ds_read_b64_tr_b16 v[88:89], v13 offset:24576
    ds_read_b64_tr_b16 v[90:91], v13 offset:25600
    v_mfma_f32_16x16x32_bf16 v[116:119], v[64:67], v[36:39], v[116:119]
    v_mfma_f32_16x16x32_bf16 v[120:123], v[64:67], v[40:43], v[120:123]
    s_waitcnt lgkmcnt(14)
    v_mfma_f32_16x16x32_bf16 v[124:127], v[68:71], v[28:31], v[124:127]
    v_mfma_f32_16x16x32_bf16 v[128:131], v[68:71], v[32:35], v[128:131]
    v_mfma_f32_16x16x32_bf16 v[132:135], v[68:71], v[36:39], v[132:135]
    v_mfma_f32_16x16x32_bf16 v[136:139], v[68:71], v[40:43], v[136:139]
    s_waitcnt lgkmcnt(12)
    v_mfma_f32_16x16x32_bf16 v[140:143], v[72:75], v[28:31], v[140:143]
    v_mfma_f32_16x16x32_bf16 v[144:147], v[72:75], v[32:35], v[144:147]
    v_mfma_f32_16x16x32_bf16 v[148:151], v[72:75], v[36:39], v[148:151]
    v_mfma_f32_16x16x32_bf16 v[152:155], v[72:75], v[40:43], v[152:155]
    s_waitcnt lgkmcnt(9)
    v_mfma_f32_16x16x32_bf16 v[92:95], v[76:79], v[44:47], v[92:95]
    s_waitcnt lgkmcnt(8)
    v_mfma_f32_16x16x32_bf16 v[96:99], v[76:79], v[48:51], v[96:99]
    s_waitcnt lgkmcnt(0)
    s_waitcnt vmcnt(8)
    s_barrier
    v_mfma_f32_16x16x32_bf16 v[100:103], v[76:79], v[52:55], v[100:103]
    ds_read_b64_tr_b16 v[60:61], v10 offset:32768
    ds_read_b64_tr_b16 v[62:63], v10 offset:33792
    v_mfma_f32_16x16x32_bf16 v[104:107], v[76:79], v[56:59], v[104:107]
    ds_read_b128 v[28:31], v8 offset:32768
    ds_read_b128 v[32:35], v8 offset:34816
    v_mfma_f32_16x16x32_bf16 v[108:111], v[80:83], v[44:47], v[108:111]
    ds_read_b128 v[36:39], v8 offset:36864
    ds_read_b128 v[40:43], v8 offset:38912
    v_mfma_f32_16x16x32_bf16 v[112:115], v[80:83], v[48:51], v[112:115]
    ds_read_b64_tr_b16 v[64:65], v11 offset:32768
    ds_read_b64_tr_b16 v[66:67], v11 offset:33792
    v_mfma_f32_16x16x32_bf16 v[116:119], v[80:83], v[52:55], v[116:119]
    ds_read_b64_tr_b16 v[68:69], v12 offset:32768
    ds_read_b64_tr_b16 v[70:71], v12 offset:33792
    v_mfma_f32_16x16x32_bf16 v[120:123], v[80:83], v[56:59], v[120:123]
    ds_read_b64_tr_b16 v[72:73], v13 offset:32768
    ds_read_b64_tr_b16 v[74:75], v13 offset:33792
    v_mfma_f32_16x16x32_bf16 v[124:127], v[84:87], v[44:47], v[124:127]
    v_mfma_f32_16x16x32_bf16 v[128:131], v[84:87], v[48:51], v[128:131]
    v_mfma_f32_16x16x32_bf16 v[132:135], v[84:87], v[52:55], v[132:135]
    v_mfma_f32_16x16x32_bf16 v[136:139], v[84:87], v[56:59], v[136:139]
    v_mfma_f32_16x16x32_bf16 v[140:143], v[88:91], v[44:47], v[140:143]
    v_mfma_f32_16x16x32_bf16 v[144:147], v[88:91], v[48:51], v[144:147]
    v_mfma_f32_16x16x32_bf16 v[148:151], v[88:91], v[52:55], v[148:151]
    v_mfma_f32_16x16x32_bf16 v[152:155], v[88:91], v[56:59], v[152:155]
    s_waitcnt lgkmcnt(9)
    v_mfma_f32_16x16x32_bf16 v[92:95], v[60:63], v[28:31], v[92:95]
    ds_read_b64_tr_b16 v[76:77], v10 offset:40960
    ds_read_b64_tr_b16 v[78:79], v10 offset:41984
    s_waitcnt lgkmcnt(10)
    v_mfma_f32_16x16x32_bf16 v[96:99], v[60:63], v[32:35], v[96:99]
    ds_read_b128 v[44:47], v9 offset:32768
    ds_read_b128 v[48:51], v9 offset:34816
    s_waitcnt lgkmcnt(11)
    v_mfma_f32_16x16x32_bf16 v[100:103], v[60:63], v[36:39], v[100:103]
    ds_read_b128 v[52:55], v9 offset:36864
    ds_read_b128 v[56:59], v9 offset:38912
    s_waitcnt lgkmcnt(12)
    v_mfma_f32_16x16x32_bf16 v[104:107], v[60:63], v[40:43], v[104:107]
    ds_read_b64_tr_b16 v[80:81], v11 offset:40960
    ds_read_b64_tr_b16 v[82:83], v11 offset:41984
    s_waitcnt lgkmcnt(12)
    v_mfma_f32_16x16x32_bf16 v[108:111], v[64:67], v[28:31], v[108:111]
    ds_read_b64_tr_b16 v[84:85], v12 offset:40960
    ds_read_b64_tr_b16 v[86:87], v12 offset:41984
    v_mfma_f32_16x16x32_bf16 v[112:115], v[64:67], v[32:35], v[112:115]
    ds_read_b64_tr_b16 v[88:89], v13 offset:40960
    ds_read_b64_tr_b16 v[90:91], v13 offset:41984
    v_mfma_f32_16x16x32_bf16 v[116:119], v[64:67], v[36:39], v[116:119]
    v_mfma_f32_16x16x32_bf16 v[120:123], v[64:67], v[40:43], v[120:123]
    s_waitcnt lgkmcnt(14)
    v_mfma_f32_16x16x32_bf16 v[124:127], v[68:71], v[28:31], v[124:127]
    v_mfma_f32_16x16x32_bf16 v[128:131], v[68:71], v[32:35], v[128:131]
    v_mfma_f32_16x16x32_bf16 v[132:135], v[68:71], v[36:39], v[132:135]
    v_mfma_f32_16x16x32_bf16 v[136:139], v[68:71], v[40:43], v[136:139]
    s_waitcnt lgkmcnt(12)
    v_mfma_f32_16x16x32_bf16 v[140:143], v[72:75], v[28:31], v[140:143]
    v_mfma_f32_16x16x32_bf16 v[144:147], v[72:75], v[32:35], v[144:147]
    v_mfma_f32_16x16x32_bf16 v[148:151], v[72:75], v[36:39], v[148:151]
    v_mfma_f32_16x16x32_bf16 v[152:155], v[72:75], v[40:43], v[152:155]
    s_waitcnt lgkmcnt(9)
    v_mfma_f32_16x16x32_bf16 v[92:95], v[76:79], v[44:47], v[92:95]
    s_waitcnt lgkmcnt(8)
    v_mfma_f32_16x16x32_bf16 v[96:99], v[76:79], v[48:51], v[96:99]
    s_waitcnt lgkmcnt(0)
    s_waitcnt vmcnt(0)
    s_barrier
    v_mfma_f32_16x16x32_bf16 v[100:103], v[76:79], v[52:55], v[100:103]
    ds_read_b64_tr_b16 v[60:61], v10 offset:49152
    ds_read_b64_tr_b16 v[62:63], v10 offset:50176
    v_mfma_f32_16x16x32_bf16 v[104:107], v[76:79], v[56:59], v[104:107]
    ds_read_b128 v[28:31], v8 offset:49152
    ds_read_b128 v[32:35], v8 offset:51200
    v_mfma_f32_16x16x32_bf16 v[108:111], v[80:83], v[44:47], v[108:111]
    ds_read_b128 v[36:39], v8 offset:53248
    ds_read_b128 v[40:43], v8 offset:55296
    v_mfma_f32_16x16x32_bf16 v[112:115], v[80:83], v[48:51], v[112:115]
    ds_read_b64_tr_b16 v[64:65], v11 offset:49152
    ds_read_b64_tr_b16 v[66:67], v11 offset:50176
    v_mfma_f32_16x16x32_bf16 v[116:119], v[80:83], v[52:55], v[116:119]
    ds_read_b64_tr_b16 v[68:69], v12 offset:49152
    ds_read_b64_tr_b16 v[70:71], v12 offset:50176
    v_mfma_f32_16x16x32_bf16 v[120:123], v[80:83], v[56:59], v[120:123]
    ds_read_b64_tr_b16 v[72:73], v13 offset:49152
    ds_read_b64_tr_b16 v[74:75], v13 offset:50176
    v_mfma_f32_16x16x32_bf16 v[124:127], v[84:87], v[44:47], v[124:127]
    v_mfma_f32_16x16x32_bf16 v[128:131], v[84:87], v[48:51], v[128:131]
    v_mfma_f32_16x16x32_bf16 v[132:135], v[84:87], v[52:55], v[132:135]
    v_mfma_f32_16x16x32_bf16 v[136:139], v[84:87], v[56:59], v[136:139]
    v_mfma_f32_16x16x32_bf16 v[140:143], v[88:91], v[44:47], v[140:143]
    v_mfma_f32_16x16x32_bf16 v[144:147], v[88:91], v[48:51], v[144:147]
    v_mfma_f32_16x16x32_bf16 v[148:151], v[88:91], v[52:55], v[148:151]
    v_mfma_f32_16x16x32_bf16 v[152:155], v[88:91], v[56:59], v[152:155]
    s_waitcnt lgkmcnt(9)
    v_mfma_f32_16x16x32_bf16 v[92:95], v[60:63], v[28:31], v[92:95]
    ds_read_b64_tr_b16 v[76:77], v10 offset:57344
    ds_read_b64_tr_b16 v[78:79], v10 offset:58368
    s_waitcnt lgkmcnt(10)
    v_mfma_f32_16x16x32_bf16 v[96:99], v[60:63], v[32:35], v[96:99]
    ds_read_b128 v[44:47], v9 offset:49152
    ds_read_b128 v[48:51], v9 offset:51200
    s_waitcnt lgkmcnt(11)
    v_mfma_f32_16x16x32_bf16 v[100:103], v[60:63], v[36:39], v[100:103]
    ds_read_b128 v[52:55], v9 offset:53248
    ds_read_b128 v[56:59], v9 offset:55296
    s_waitcnt lgkmcnt(12)
    v_mfma_f32_16x16x32_bf16 v[104:107], v[60:63], v[40:43], v[104:107]
    ds_read_b64_tr_b16 v[80:81], v11 offset:57344
    ds_read_b64_tr_b16 v[82:83], v11 offset:58368
    s_waitcnt lgkmcnt(12)
    v_mfma_f32_16x16x32_bf16 v[108:111], v[64:67], v[28:31], v[108:111]
    ds_read_b64_tr_b16 v[84:85], v12 offset:57344
    ds_read_b64_tr_b16 v[86:87], v12 offset:58368
    v_mfma_f32_16x16x32_bf16 v[112:115], v[64:67], v[32:35], v[112:115]
    ds_read_b64_tr_b16 v[88:89], v13 offset:57344
    ds_read_b64_tr_b16 v[90:91], v13 offset:58368
    v_mfma_f32_16x16x32_bf16 v[116:119], v[64:67], v[36:39], v[116:119]
    v_mfma_f32_16x16x32_bf16 v[120:123], v[64:67], v[40:43], v[120:123]
    s_waitcnt lgkmcnt(14)
    v_mfma_f32_16x16x32_bf16 v[124:127], v[68:71], v[28:31], v[124:127]
    v_mfma_f32_16x16x32_bf16 v[128:131], v[68:71], v[32:35], v[128:131]
    v_mfma_f32_16x16x32_bf16 v[132:135], v[68:71], v[36:39], v[132:135]
    v_mfma_f32_16x16x32_bf16 v[136:139], v[68:71], v[40:43], v[136:139]
    s_waitcnt lgkmcnt(12)
    v_mfma_f32_16x16x32_bf16 v[140:143], v[72:75], v[28:31], v[140:143]
    v_mfma_f32_16x16x32_bf16 v[144:147], v[72:75], v[32:35], v[144:147]
    v_mfma_f32_16x16x32_bf16 v[148:151], v[72:75], v[36:39], v[148:151]
    v_mfma_f32_16x16x32_bf16 v[152:155], v[72:75], v[40:43], v[152:155]
    s_waitcnt lgkmcnt(9)
    v_mfma_f32_16x16x32_bf16 v[92:95], v[76:79], v[44:47], v[92:95]
    s_waitcnt lgkmcnt(8)
    v_mfma_f32_16x16x32_bf16 v[96:99], v[76:79], v[48:51], v[96:99]
    s_waitcnt lgkmcnt(7)
    v_mfma_f32_16x16x32_bf16 v[100:103], v[76:79], v[52:55], v[100:103]
    s_waitcnt lgkmcnt(6)
    v_mfma_f32_16x16x32_bf16 v[104:107], v[76:79], v[56:59], v[104:107]
    s_waitcnt lgkmcnt(4)
    v_mfma_f32_16x16x32_bf16 v[108:111], v[80:83], v[44:47], v[108:111]
    v_mfma_f32_16x16x32_bf16 v[112:115], v[80:83], v[48:51], v[112:115]
    v_mfma_f32_16x16x32_bf16 v[116:119], v[80:83], v[52:55], v[116:119]
    v_mfma_f32_16x16x32_bf16 v[120:123], v[80:83], v[56:59], v[120:123]
    s_waitcnt lgkmcnt(2)
    v_mfma_f32_16x16x32_bf16 v[124:127], v[84:87], v[44:47], v[124:127]
    v_mfma_f32_16x16x32_bf16 v[128:131], v[84:87], v[48:51], v[128:131]
    v_mfma_f32_16x16x32_bf16 v[132:135], v[84:87], v[52:55], v[132:135]
    v_mfma_f32_16x16x32_bf16 v[136:139], v[84:87], v[56:59], v[136:139]
    s_waitcnt lgkmcnt(0)
    v_mfma_f32_16x16x32_bf16 v[140:143], v[88:91], v[44:47], v[140:143]
    v_mfma_f32_16x16x32_bf16 v[144:147], v[88:91], v[48:51], v[144:147]
    v_mfma_f32_16x16x32_bf16 v[148:151], v[88:91], v[52:55], v[148:151]
    v_mfma_f32_16x16x32_bf16 v[152:155], v[88:91], v[56:59], v[152:155]
    v_cvt_pk_bf16_f32 v36, v92, v93
    v_cvt_pk_bf16_f32 v37, v94, v95
    v_cvt_pk_bf16_f32 v38, v108, v109
    v_cvt_pk_bf16_f32 v39, v110, v111
    s_nop 0
    v_permlane16_swap_b32 v36, v38
    v_permlane16_swap_b32 v37, v39
    buffer_store_dwordx4 v[36:39], v22, s[12:15], s27 offen offset:0
    v_cvt_pk_bf16_f32 v48, v96, v97
    v_cvt_pk_bf16_f32 v49, v98, v99
    v_cvt_pk_bf16_f32 v50, v112, v113
    v_cvt_pk_bf16_f32 v51, v114, v115
    s_nop 0
    v_permlane16_swap_b32 v48, v50
    v_permlane16_swap_b32 v49, v51
    buffer_store_dwordx4 v[48:51], v23, s[12:15], s27 offen offset:0
    v_cvt_pk_bf16_f32 v60, v100, v101
    v_cvt_pk_bf16_f32 v61, v102, v103
    v_cvt_pk_bf16_f32 v62, v116, v117
    v_cvt_pk_bf16_f32 v63, v118, v119
    s_nop 0
    v_permlane16_swap_b32 v60, v62
    v_permlane16_swap_b32 v61, v63
    buffer_store_dwordx4 v[60:63], v24, s[12:15], s27 offen offset:0
    v_cvt_pk_bf16_f32 v72, v104, v105
    v_cvt_pk_bf16_f32 v73, v106, v107
    v_cvt_pk_bf16_f32 v74, v120, v121
    v_cvt_pk_bf16_f32 v75, v122, v123
    s_nop 0
    v_permlane16_swap_b32 v72, v74
    v_permlane16_swap_b32 v73, v75
    buffer_store_dwordx4 v[72:75], v25, s[12:15], s27 offen offset:0
    v_cvt_pk_bf16_f32 v36, v124, v125
    v_cvt_pk_bf16_f32 v37, v126, v127
    v_cvt_pk_bf16_f32 v38, v140, v141
    v_cvt_pk_bf16_f32 v39, v142, v143
    s_nop 0
    v_permlane16_swap_b32 v36, v38
    v_permlane16_swap_b32 v37, v39
    buffer_store_dwordx4 v[36:39], v22, s[12:15], s27 offen offset:64
    v_cvt_pk_bf16_f32 v48, v128, v129
    v_cvt_pk_bf16_f32 v49, v130, v131
    v_cvt_pk_bf16_f32 v50, v144, v145
    v_cvt_pk_bf16_f32 v51, v146, v147
    s_nop 0
    v_permlane16_swap_b32 v48, v50
    v_permlane16_swap_b32 v49, v51
    buffer_store_dwordx4 v[48:51], v23, s[12:15], s27 offen offset:64
    v_cvt_pk_bf16_f32 v60, v132, v133
    v_cvt_pk_bf16_f32 v61, v134, v135
    v_cvt_pk_bf16_f32 v62, v148, v149
    v_cvt_pk_bf16_f32 v63, v150, v151
    s_nop 0
    v_permlane16_swap_b32 v60, v62
    v_permlane16_swap_b32 v61, v63
    buffer_store_dwordx4 v[60:63], v24, s[12:15], s27 offen offset:64
    v_cvt_pk_bf16_f32 v72, v136, v137
    v_cvt_pk_bf16_f32 v73, v138, v139
    v_cvt_pk_bf16_f32 v74, v152, v153
    v_cvt_pk_bf16_f32 v75, v154, v155
    s_nop 0
    v_permlane16_swap_b32 v72, v74
    v_permlane16_swap_b32 v73, v75
    buffer_store_dwordx4 v[72:75], v25, s[12:15], s27 offen offset:64
L_g2_end:
    s_endpgm
.section .rodata,"a"
.p2align 6
.amdhsa_kernel gemm2_kernel
  .amdhsa_next_free_vgpr 156
  .amdhsa_next_free_sgpr 53
  .amdhsa_accum_offset 156
  .amdhsa_group_segment_fixed_size 0
  .amdhsa_kernarg_size 88
  .amdhsa_user_sgpr_count 2
  .amdhsa_user_sgpr_kernarg_segment_ptr 1
  .amdhsa_system_sgpr_workgroup_id_x 1
.end_amdhsa_kernel
.text
.globl comb_kernel
.p2align 8
.type comb_kernel,@function
comb_kernel:
    s_load_dwordx2 s[4:5], s[0:1], 0
    s_load_dwordx2 s[6:7], s[0:1], 80
    s_load_dwordx2 s[24:25], s[0:1], 64
    s_cmp_ge_u32 s2, 1024
    s_cbranch_scc1 L_cb_end
    s_waitcnt lgkmcnt(0)
    s_mov_b32 s8, s4
    s_mov_b32 s9, s5
    s_mov_b32 s10, 0x400000
    s_mov_b32 s11, 0x00020000
    s_add_u32 s12, s6, 0x3400000
    s_addc_u32 s13, s7, 0
    s_mov_b32 s14, 0x400000
    s_mov_b32 s15, 0x00020000
    s_add_u32 s16, s6, 0x3800000
    s_addc_u32 s17, s7, 0
    s_mov_b32 s18, 0x400000
    s_mov_b32 s19, 0x00020000
    s_mov_b32 s20, s24
    s_mov_b32 s21, s25
    s_mov_b32 s22, 0x400000
    s_mov_b32 s23, 0x00020000
    s_lshl_b32 s26, s2, 12
    v_lshlrev_b32 v1, 4, v0
    v_add_u32 v1, s26, v1
    buffer_load_dwordx4 v[4:7], v1, s[8:11], 0 offen
    buffer_load_dwordx4 v[8:11], v1, s[12:15], 0 offen
    buffer_load_dwordx4 v[12:15], v1, s[16:19], 0 offen
    s_mov_b32 s27, 0xbfb8aa3b
    s_waitcnt vmcnt(0)
    v_lshlrev_b32 v16, 16, v12
    v_lshlrev_b32 v17, 16, v8
    v_lshlrev_b32 v18, 16, v4
    v_mul_f32 v19, s27, v16
    v_exp_f32 v19, v19
    s_nop 0
    v_add_f32 v19, 1.0, v19
    v_rcp_f32 v19, v19
    s_nop 0
    v_mul_f32 v19, v16, v19
    v_cvt_pk_bf16_f32 v19, v19, v19
    v_lshlrev_b32 v19, 16, v19
    v_mul_f32 v19, v17, v19
    v_cvt_pk_bf16_f32 v19, v19, v19
    v_lshlrev_b32 v19, 16, v19
    v_add_f32 v20, v18, v19
    v_and_b32 v16, 0xffff0000, v12
    v_and_b32 v17, 0xffff0000, v8
    v_and_b32 v18, 0xffff0000, v4
    v_mul_f32 v19, s27, v16
    v_exp_f32 v19, v19
    s_nop 0
    v_add_f32 v19, 1.0, v19
    v_rcp_f32 v19, v19
    s_nop 0
    v_mul_f32 v19, v16, v19
    v_cvt_pk_bf16_f32 v19, v19, v19
    v_lshlrev_b32 v19, 16, v19
    v_mul_f32 v19, v17, v19
    v_cvt_pk_bf16_f32 v19, v19, v19
    v_lshlrev_b32 v19, 16, v19
    v_add_f32 v21, v18, v19
    v_cvt_pk_bf16_f32 v24, v20, v21
    v_lshlrev_b32 v16, 16, v13
    v_lshlrev_b32 v17, 16, v9
    v_lshlrev_b32 v18, 16, v5
    v_mul_f32 v19, s27, v16
    v_exp_f32 v19, v19
    s_nop 0
    v_add_f32 v19, 1.0, v19
    v_rcp_f32 v19, v19
    s_nop 0
    v_mul_f32 v19, v16, v19
    v_cvt_pk_bf16_f32 v19, v19, v19
    v_lshlrev_b32 v19, 16, v19
    v_mul_f32 v19, v17, v19
    v_cvt_pk_bf16_f32 v19, v19, v19
    v_lshlrev_b32 v19, 16, v19
    v_add_f32 v20, v18, v19
    v_and_b32 v16, 0xffff0000, v13
    v_and_b32 v17, 0xffff0000, v9
    v_and_b32 v18, 0xffff0000, v5
    v_mul_f32 v19, s27, v16
    v_exp_f32 v19, v19
    s_nop 0
    v_add_f32 v19, 1.0, v19
    v_rcp_f32 v19, v19
    s_nop 0
    v_mul_f32 v19, v16, v19
    v_cvt_pk_bf16_f32 v19, v19, v19
    v_lshlrev_b32 v19, 16, v19
    v_mul_f32 v19, v17, v19
    v_cvt_pk_bf16_f32 v19, v19, v19
    v_lshlrev_b32 v19, 16, v19
    v_add_f32 v21, v18, v19
    v_cvt_pk_bf16_f32 v25, v20, v21
    v_lshlrev_b32 v16, 16, v14
    v_lshlrev_b32 v17, 16, v10
    v_lshlrev_b32 v18, 16, v6
    v_mul_f32 v19, s27, v16
    v_exp_f32 v19, v19
    s_nop 0
    v_add_f32 v19, 1.0, v19
    v_rcp_f32 v19, v19
    s_nop 0
    v_mul_f32 v19, v16, v19
    v_cvt_pk_bf16_f32 v19, v19, v19
    v_lshlrev_b32 v19, 16, v19
    v_mul_f32 v19, v17, v19
    v_cvt_pk_bf16_f32 v19, v19, v19
    v_lshlrev_b32 v19, 16, v19
    v_add_f32 v20, v18, v19
    v_and_b32 v16, 0xffff0000, v14
    v_and_b32 v17, 0xffff0000, v10
    v_and_b32 v18, 0xffff0000, v6
    v_mul_f32 v19, s27, v16
    v_exp_f32 v19, v19
    s_nop 0
    v_add_f32 v19, 1.0, v19
    v_rcp_f32 v19, v19
    s_nop 0
    v_mul_f32 v19, v16, v19
    v_cvt_pk_bf16_f32 v19, v19, v19
    v_lshlrev_b32 v19, 16, v19
    v_mul_f32 v19, v17, v19
    v_cvt_pk_bf16_f32 v19, v19, v19
    v_lshlrev_b32 v19, 16, v19
    v_add_f32 v21, v18, v19
    v_cvt_pk_bf16_f32 v26, v20, v21
    v_lshlrev_b32 v16, 16, v15
    v_lshlrev_b32 v17, 16, v11
    v_lshlrev_b32 v18, 16, v7
    v_mul_f32 v19, s27, v16
    v_exp_f32 v19, v19
    s_nop 0
    v_add_f32 v19, 1.0, v19
    v_rcp_f32 v19, v19
    s_nop 0
    v_mul_f32 v19, v16, v19
    v_cvt_pk_bf16_f32 v19, v19, v19
    v_lshlrev_b32 v19, 16, v19
    v_mul_f32 v19, v17, v19
    v_cvt_pk_bf16_f32 v19, v19, v19
    v_lshlrev_b32 v19, 16, v19
    v_add_f32 v20, v18, v19
    v_and_b32 v16, 0xffff0000, v15
    v_and_b32 v17, 0xffff0000, v11
    v_and_b32 v18, 0xffff0000, v7
    v_mul_f32 v19, s27, v16
    v_exp_f32 v19, v19
    s_nop 0
    v_add_f32 v19, 1.0, v19
    v_rcp_f32 v19, v19
    s_nop 0
    v_mul_f32 v19, v16, v19
    v_cvt_pk_bf16_f32 v19, v19, v19
    v_lshlrev_b32 v19, 16, v19
    v_mul_f32 v19, v17, v19
    v_cvt_pk_bf16_f32 v19, v19, v19
    v_lshlrev_b32 v19, 16, v19
    v_add_f32 v21, v18, v19
    v_cvt_pk_bf16_f32 v27, v20, v21
    buffer_store_dwordx4 v[24:27], v1, s[20:23], 0 offen
L_cb_end:
    s_endpgm
.section .rodata,"a"
.p2align 6
.amdhsa_kernel comb_kernel
  .amdhsa_next_free_vgpr 28
  .amdhsa_next_free_sgpr 28
  .amdhsa_accum_offset 28
  .amdhsa_group_segment_fixed_size 0
  .amdhsa_kernarg_size 88
  .amdhsa_user_sgpr_count 2
  .amdhsa_user_sgpr_kernarg_segment_ptr 1
  .amdhsa_system_sgpr_workgroup_id_x 1
.end_amdhsa_kernel
```
